```python
import torch

def _softmax(x, axis=-1):
    return torch.softmax(x, dim=axis)
def _gelu(x):
    return torch.nn.functional.gelu(x, approximate="tanh")
def _silu(x):
    return torch.nn.functional.silu(x)
def _sigmoid(x):
    return torch.sigmoid(x)
def _layernorm(x, axis=-1, eps=1e-5):
    m = x.mean(dim=axis, keepdim=True)
    v = x.var(dim=axis, keepdim=True, unbiased=False)
    return (x - m) / torch.sqrt(v + eps)
def _scatter_add(tgt, idx, src, axis=0):
    return tgt.clone().index_add_(axis, idx, src)
def _segment_sum(src, seg, n):
    out = torch.zeros((n,) + src.shape[1:], dtype=src.dtype)
    return out.index_add_(0, seg, src)
def _pad(x, pw):
    flat = tuple(v for pair in reversed(pw) for v in pair)
    return torch.nn.functional.pad(x, flat)

kernel_name = 'recurrent_scan__ssm_conv_h3__geglu_ffn__prompt'

def setup_inputs():

    _w = (lambda a: (lambda t: t.to(torch.bfloat16) if t.is_floating_point() else t)(torch.as_tensor(a)))
    def _A_setup():
        B, S, D = 1, 2048, 512
        ks = 4
        return {
            "q": _w((lambda *s: torch.randn(*s, dtype=torch.bfloat16) * 0.05)(B, S, D)),
            "k": _w((lambda *s: torch.randn(*s, dtype=torch.bfloat16) * 0.2)(B, S, D)),
            "v": _w((lambda *s: torch.randn(*s, dtype=torch.bfloat16) * 0.2)(B, S, D)),
            "shift_k": _w((lambda *s: torch.randn(*s, dtype=torch.bfloat16) * 0.2)(D, ks) * 0.5),
            "ssm_k": _w((lambda *s: torch.randn(*s, dtype=torch.bfloat16) * 0.2)(D, S) * (1.0 / S ** 0.5)),
            "ssm_D": _w((lambda *s: torch.randn(*s, dtype=torch.bfloat16) * 0.2)(D)),
        }
    _A_in = _A_setup()

    def _B_setup():
        B, S, D, F = 1, 2048, 512, 1792
        return {
            "x": _w((lambda *s: torch.randn(*s, dtype=torch.bfloat16) * 0.05)(B, S, D)),
            "w_gate": _w((lambda *s: torch.randn(*s, dtype=torch.bfloat16) * 0.1)(D, F)),
            "w_up": _w((lambda *s: torch.randn(*s, dtype=torch.bfloat16) * 0.1)(D, F)),
            "w_down": _w((lambda *s: torch.randn(*s, dtype=torch.bfloat16) * 0.1)(F, D)),
        }
    _B_in = _B_setup()

    return {
        "A_q": _A_in["q"],
        "A_k": _A_in["k"],
        "A_v": _A_in["v"],
        "A_shift_k": _A_in["shift_k"],
        "A_ssm_k": _A_in["ssm_k"],
        "A_ssm_D": _A_in["ssm_D"],
        "B_x": _B_in["x"],
        "B_w_gate": _B_in["w_gate"],
        "B_w_up": _B_in["w_up"],
        "B_w_down": _B_in["w_down"],
    }

def reference(A_q, A_k, A_v, A_shift_k, A_ssm_k, A_ssm_D, B_x, B_w_gate, B_w_up, B_w_down):
    def _A_ref(q, k, v, shift_k, ssm_k, ssm_D):
        B, S, D = q.shape
        ks = shift_k.shape[-1]
        k_pad = _pad(k, ((0, 0), (ks - 1, 0), (0, 0)))
        k_shift = torch.zeros_like(k)
        for t in range(ks):
            k_shift = k_shift + k_pad[:, t:t + S, :] * shift_k[:, ks - 1 - t][None, None, :]
        kv = k_shift * v
        L = 2 * S
        kv_pad = _pad(kv, ((0, 0), (0, S), (0, 0)))
        kf_pad = _pad(ssm_k, ((0, 0), (0, S)))
        kv_f = (lambda x, axes=(-2,-1): torch.fft.rfft2(x.float(), dim=axes))(kv_pad[:, None, :, :], axes=(1, 2))
        kf_f = (lambda x, axes=(-2,-1): torch.fft.rfft2(x.float(), dim=axes))(kf_pad[:, None, :], axes=(1, 2))
        kf_f = (lambda x, *d: x.permute(*d))(kf_f, 1, 2, 0)
        y_f = kv_f * kf_f[None, :, :, :]
        y = (lambda x, s, axes=(-2,-1): torch.fft.irfft2(x, s=s, dim=axes).to(torch.bfloat16))(y_f, (1, L), axes=(1, 2))[:, 0, :S, :]
        y = y + kv * ssm_D[None, None, :]
        return q * y

    def _B_ref(x, w_gate, w_up, w_down):
        return (_gelu(x @ w_gate) * (x @ w_up)) @ w_down

    x = A_q
    xn = _layernorm(x, axis=-1)
    s = _A_ref(xn, A_k, A_v, A_shift_k, A_ssm_k, A_ssm_D)
    g = _silu(_B_ref(xn, B_w_gate, B_w_up, B_w_down))
    return x + s * g
```

```asm
; @launch grid=(256,1,1) block=(512,1,1) lds=163840
.amdgcn_target "amdgcn-amd-amdhsa--gfx950"
.text
.globl recurrent_scan__ssm_conv_h3__geglu_ffn__prompt_kernel
.p2align 8
.type recurrent_scan__ssm_conv_h3__geglu_ffn__prompt_kernel,@function
recurrent_scan__ssm_conv_h3__geglu_ffn__prompt_kernel:
  s_cmp_ge_u32 s2, 256
  s_cbranch_scc1 L_end
  s_load_dwordx2 s[40:41], s[0:1], 0
  s_load_dwordx4 s[4:7], s[0:1], 56
  s_load_dwordx2 s[48:49], s[0:1], 96
  s_load_dwordx2 s[52:53], s[0:1], 32
  s_load_dwordx2 s[38:39], s[0:1], 40
  s_load_dwordx2 s[56:57], s[0:1], 80
  s_load_dwordx2 s[60:61], s[0:1], 88
  v_lshrrev_b32 v2, 6, v0
  v_and_b32 v1, 63, v0
  s_and_b32 s21, s2, 7
  v_readfirstlane_b32 s20, v2
  s_lshr_b32 s22, s2, 3
  s_and_b32 s30, s2, 1
  s_lshr_b32 s31, s21, 1
  s_and_b32 s23, s22, 3
  s_lshr_b32 s24, s22, 2
  s_and_b32 s27, s20, 1
  s_bfe_u32 s28, s20, 0x10001
  s_lshr_b32 s29, s20, 2
  s_lshl2_add_u32 s35, s31, s23
  s_mov_b32 s42, 2097152
  s_mov_b32 s43, 0x20000
  s_mov_b32 s46, 1835008
  s_mov_b32 s47, 0x20000
  s_mov_b32 s50, 25165824
  s_mov_b32 s51, 0x20000
  s_cmp_eq_u32 s24, 0
  s_cbranch_scc1 L_spare
  s_load_dwordx2 s[64:65], s[0:1], 72
  s_mul_i32 s34, s30, 7
  s_add_u32 s34, s34, s24
  s_sub_u32 s34, s34, 1
  v_lshrrev_b32 v112, 3, v1
  v_and_b32 v113, 7, v1
  v_and_b32 v115, 2, v112
  s_lshl_b32 s8, s27, 2
  v_xor_b32 v115, s8, v115
  v_xor_b32 v115, v115, v113
  s_lshl_b32 s8, s28, 5
  v_add_u32 v116, s8, v112
  v_mul_u32_u24 v116, 3584, v116
  v_lshl_add_u32 v2, v115, 4, v116
  v_add_u32 v3, 27648, v2
  v_add_u32 v4, 55296, v2
  v_add_u32 v5, 82944, v2
  v_lshrrev_b32 v114, 1, v112
  s_xor_b32 s8, s30, 1
  s_lshl_b32 s8, s8, 1
  s_xor_b32 s8, s8, s20
  s_lshl_b32 s8, s8, 4
  v_add_u32 v116, s8, v112
  v_lshlrev_b32 v116, 10, v116
  v_xor_b32 v115, v114, v113
  v_lshl_add_u32 v6, v115, 4, v116
  v_xor_b32 v7, 64, v6
  v_add_u32 v7, 7168, v7
  s_lshl_b32 s32, s20, 11
  s_bitset1_b32 s32, 15
  s_lshl1_add_u32 s33, s29, s27
  s_lshl1_add_u32 s33, s33, s28
  s_lshl_b32 s33, s33, 12
  s_lshl1_add_u32 s36, s34, s29
  s_lshl_b32 s36, s36, 7
  s_lshl_b32 s37, s35, 17
  s_add_u32 s8, s23, s24
  s_and_b32 s25, s8, 1
  s_and_b32 s26, s8, 1
  s_xor_b32 s8, s31, s30
  s_and_b32 s8, s8, 1
  s_lshl2_add_u32 s25, s8, s25
  s_lshl2_add_u32 s26, s8, s26
  s_cmp_eq_u32 s27, 0
  s_waitcnt lgkmcnt(0)
  s_cselect_b32 s44, s4, s6
  s_cselect_b32 s45, s5, s7
  s_waitcnt lgkmcnt(0)
  s_and_b32 s8, s22, 4
  s_cbranch_scc0 L_xa
  s_xor_b32 s8, s25, 0
  s_mul_i32 s11, s8, 229376
  s_add_u32 s11, s11, s36
  s_add_u32 m0, s33, 16384
  s_nop 0
  buffer_load_dwordx4 v2, s[44:47], s11 offen offset:0 lds
  buffer_load_dwordx4 v3, s[44:47], s11 offen offset:1024 lds
  buffer_load_dwordx4 v4, s[44:47], s11 offen offset:2048 lds
  buffer_load_dwordx4 v5, s[44:47], s11 offen offset:3072 lds
  s_xor_b32 s8, s25, 0
  s_lshl_b32 s12, s8, 7
  s_add_u32 s12, s12, s37
  s_add_u32 m0, s32, 16384
  s_nop 0
  buffer_load_dwordx4 v6, s[40:43], s12 offen offset:0 lds
  buffer_load_dwordx4 v7, s[40:43], s12 offen offset:1024 lds
  s_branch L_xb
L_xa:
  s_xor_b32 s8, s25, 0
  s_lshl_b32 s12, s8, 7
  s_add_u32 s12, s12, s37
  s_add_u32 m0, s32, 16384
  s_nop 0
  buffer_load_dwordx4 v6, s[40:43], s12 offen offset:0 lds
  buffer_load_dwordx4 v7, s[40:43], s12 offen offset:1024 lds
  s_xor_b32 s8, s25, 0
  s_mul_i32 s11, s8, 229376
  s_add_u32 s11, s11, s36
  s_add_u32 m0, s33, 16384
  s_nop 0
  buffer_load_dwordx4 v2, s[44:47], s11 offen offset:0 lds
  buffer_load_dwordx4 v3, s[44:47], s11 offen offset:1024 lds
  buffer_load_dwordx4 v4, s[44:47], s11 offen offset:2048 lds
  buffer_load_dwordx4 v5, s[44:47], s11 offen offset:3072 lds
L_xb:
  s_mov_b32 s54, 2097152
  s_mov_b32 s55, 0x20000
  s_mov_b32 s58, 2097152
  s_mov_b32 s59, 0x20000
  s_mov_b32 s62, 256
  s_mov_b32 s63, 0x20000
  v_lshlrev_b32 v14, 4, v1
  s_and_b32 s90, s20, 3
  s_lshl_b32 s87, s21, 5
  s_add_u32 s87, s87, s22
  s_lshl_b32 s8, s87, 2
  s_load_dword s19, s[38:39], s8
  v_lshrrev_b32 v112, 4, v1
  v_and_b32 v113, 1, v112
  v_lshrrev_b32 v112, 1, v112
  v_bfe_u32 v114, v1, 2, 2
  v_and_b32 v115, 3, v1
  v_lshlrev_b32 v116, 13, v113
  v_lshl_add_u32 v116, v112, 10, v116
  v_lshl_add_u32 v116, v114, 7, v116
  v_lshl_add_u32 v116, v115, 3, v116
  v_lshrrev_b32 v114, 1, v114
  v_lshl_add_u32 v114, v113, 1, v114
  v_lshl_add_u32 v116, v114, 5, v116
  s_lshl_b32 s8, s28, 14
  s_add_u32 s8, s8, 16384
  s_lshl_b32 s9, s29, 6
  v_xor_b32 v116, s9, v116
  v_add_u32 v8, s8, v116
  v_xor_b32 v9, 32, v8
  v_and_b32 v113, 31, v1
  v_bfe_u32 v114, v1, 1, 3
  v_xor_b32 v114, v114, v112
  v_lshlrev_b32 v114, 4, v114
  v_lshl_add_u32 v114, v113, 7, v114
  s_lshl_b32 s8, s27, 13
  s_add_u32 s8, s8, 49152
  v_add_u32 v10, s8, v114
  v_xor_b32 v11, 32, v10
  v_xor_b32 v12, 64, v10
  v_xor_b32 v13, 96, v10
  s_lshl_b32 s91, s20, 10
  s_mul_i32 s8, s30, 112
  s_add_u32 s8, s8, s20
  s_lshl_b32 s8, s8, 6
  s_add_u32 s8, s8, s24
  s_lshl_b32 s8, s8, 7
  v_lshrrev_b32 v116, 3, v1
  v_lshrrev_b32 v117, 2, v1
  v_and_b32 v117, 4, v117
  v_and_b32 v0, 7, v1
  v_xor_b32 v0, v0, v117
  v_lshl_add_u32 v0, v0, 4, s8
  v_lshl_add_u32 v0, v116, 10, v0
  s_mov_b32 s66, 1835008
  s_mov_b32 s67, 0x20000
  s_mul_i32 s8, s23, 2
  s_mul_i32 s9, s24, 1
  s_add_u32 s8, s8, s9
  s_mul_i32 s9, s31, 1
  s_add_u32 s8, s8, s9
  s_mul_i32 s9, s8, 37
  s_lshr_b32 s9, s9, 8
  s_mul_i32 s9, s9, 7
  s_sub_u32 s8, s8, s9
  s_lshl_b32 s76, s8, 12
  s_add_u32 s8, s76, 4096
  s_cmp_eq_u32 s8, 28672
  s_cselect_b32 s77, 0, s8
  s_add_u32 s8, s77, 4096
  s_cmp_eq_u32 s8, 28672
  s_cselect_b32 s78, 0, s8
  s_add_u32 s8, s78, 4096
  s_cmp_eq_u32 s8, 28672
  s_cselect_b32 s79, 0, s8
  s_add_u32 s8, s79, 4096
  s_cmp_eq_u32 s8, 28672
  s_cselect_b32 s80, 0, s8
  s_add_u32 s8, s80, 4096
  s_cmp_eq_u32 s8, 28672
  s_cselect_b32 s81, 0, s8
  s_add_u32 s8, s81, 4096
  s_cmp_eq_u32 s8, 28672
  s_cselect_b32 s82, 0, s8
  s_lshl1_add_u32 s8, s35, s27
  s_lshl1_add_u32 s9, s8, s30
  s_xor_b32 s8, s9, 1
  s_xor_b32 s89, s8, s29
  s_lshl1_add_u32 s10, s28, s29
  s_lshl2_add_u32 s11, s34, s10
  s_lshl_b32 s11, s11, 11
  s_mul_i32 s83, s8, 114688
  s_add_u32 s83, s83, s11
  s_mul_i32 s84, s9, 114688
  s_add_u32 s84, s84, s11
  s_lshl4_add_u32 s8, s8, s34
  s_lshl4_add_u32 s8, s8, s10
  s_lshl_b32 s8, s8, 2
  s_add_u32 s85, s8, 12648448
  s_xor_b32 s86, s85, 1024
  v_and_b32 v112, 15, v1
  v_lshrrev_b32 v113, 4, v1
  v_and_b32 v114, 1, v113
  v_lshlrev_b32 v129, 2, v112
  v_lshl_add_u32 v129, v114, 7, v129
  s_xor_b32 s8, s30, 1
  s_lshl_b32 s8, s8, 9
  v_and_b32 v115, 7, v1
  v_lshlrev_b32 v115, 3, v115
  v_sub_u32 v115, v14, v115
  v_xor_b32 v130, s8, v115
  s_lshl1_add_u32 s9, s30, s28
  s_mul_i32 s8, s9, 14
  v_min_u32 v115, 13, v1
  v_add_u32 v115, s8, v115
  v_lshrrev_b32 v117, 2, v115
  v_and_b32 v115, 3, v115
  s_lshl_b32 s8, s89, 10
  s_add_u32 s8, s8, 12648448
  v_lshl_add_u32 v115, v115, 2, s8
  v_lshl_add_u32 v131, v117, 6, v115
  s_lshl2_add_u32 s8, s89, s9
  s_mul_i32 s8, s8, 28672
  v_add_u32 v135, s8, v14
  v_add3_u32 v142, v112, v113, -15
  s_mul_i32 s8, s29, 24576
  s_add_u32 s8, s8, 114688
  v_mul_u32_u24 v115, 4160, v114
  v_lshrrev_b32 v116, 1, v113
  v_mul_u32_u24 v117, 15488, v116
  v_add3_u32 v115, v115, v117, s8
  v_lshl_add_u32 v141, v112, 1, v115
  s_cmp_lt_u32 s20, 4
  s_cbranch_scc0 L_sc_1
  s_add_u32 s8, s24, 3
  s_and_b32 s8, s8, 3
  s_lshl2_add_u32 s8, s8, s90
  s_lshl_b32 s8, s8, 10
  s_add_u32 s8, s8, 49152
  v_add_u32 v15, s8, v14
  v_mov_b32 v134, 0
  s_branch L_sj_2
L_sc_1:
  v_lshrrev_b32 v115, 2, v1
  v_and_b32 v117, 3, v1
  v_and_b32 v118, 2, v115
  v_xor_b32 v117, v117, v118
  v_lshlrev_b32 v117, 4, v117
  v_lshl_add_u32 v117, v115, 7, v117
  s_lshr_b32 s8, s31, 1
  s_xor_b32 s8, s8, s23
  s_and_b32 s8, s8, 1
  s_lshl_b32 s8, s8, 6
  s_lshl2_add_u32 s9, s23, s90
  s_lshl_b32 s9, s9, 11
  s_add_u32 s8, s8, s9
  s_add_u32 s8, s8, 16384
  v_add_u32 v15, s8, v117
  s_mul_i32 s8, s28, 96
  s_add_u32 s8, s8, s27
  s_lshl_b32 s8, s8, 8
  s_add_u32 s8, s8, 114688
  v_and_b32 v115, 1, v1
  v_mul_u32_u24 v117, 4160, v115
  v_bfe_u32 v118, v1, 1, 1
  v_mul_u32_u24 v118, 15488, v118
  v_add3_u32 v117, v117, v118, s8
  v_lshl_add_u32 v117, v113, 4, v117
  v_bfe_u32 v118, v1, 2, 2
  v_lshl_add_u32 v132, v118, 3, v117
  s_add_u32 s8, s8, 10720
  v_lshl_add_u32 v117, v113, 4, s8
  v_lshlrev_b32 v118, 5, v112
  v_sub_u32 v133, v117, v118
  v_lshrrev_b32 v117, 1, v112
  v_lshlrev_b32 v117, 15, v117
  v_lshl_add_u32 v117, v115, 5, v117
  v_lshl_add_u32 v134, v113, 3, v117
  s_lshl_b32 s9, s28, 4
  s_waitcnt lgkmcnt(0)
  s_lshr_b32 s19, s19, s9
  s_and_b32 s19, s19, 0xffff
  s_cmp_eq_u32 s27, 0
  s_cselect_b32 s19, s19, 0
  v_lshl_add_u32 v117, v113, 3, v112
  v_sub_u32 v117, 15, v117
  v_and_b32 v118, 1, v117
  v_lshlrev_b32 v118, 4, v118
  v_lshlrev_b32 v118, v118, s19
  v_ashrrev_i32 v117, 1, v117
  v_cmp_eq_u32 vcc, 0, v117
  s_nop 1
  v_cndmask_b32 v136, 0, v118, vcc
  v_cmp_eq_u32 vcc, 1, v117
  s_nop 1
  v_cndmask_b32 v137, 0, v118, vcc
  v_cmp_eq_u32 vcc, 2, v117
  s_nop 1
  v_cndmask_b32 v138, 0, v118, vcc
  v_cmp_eq_u32 vcc, 3, v117
  s_nop 1
  v_cndmask_b32 v139, 0, v118, vcc
L_sj_2:
  s_nop 1
  s_waitcnt lgkmcnt(0)
  s_lshl_b32 s7, s21, 5
  s_add_u32 s7, s7, s22
  s_lshl_b32 s8, s20, 11
  s_add_u32 s7, s7, s8
  s_lshl_b32 s7, s7, 7
  s_add_u32 s7, s7, 20971520
  v_lshrrev_b32 v148, 3, v1
  v_mul_u32_u24 v148, 32640, v148
  v_add_u32 v148, v148, v14
  v_mov_b32 v144, -1
  v_mov_b32 v145, -1
  v_mov_b32 v146, -1
  v_mov_b32 v147, -1
  s_barrier
  s_xor_b32 s8, s25, 1
  s_mul_i32 s11, s8, 229376
  s_add_u32 s11, s11, s36
  s_add_u32 m0, s33, 65536
  s_nop 0
  buffer_load_dwordx4 v2, s[44:47], s11 offen offset:0 lds
  buffer_load_dwordx4 v3, s[44:47], s11 offen offset:1024 lds
  buffer_load_dwordx4 v4, s[44:47], s11 offen offset:2048 lds
  buffer_load_dwordx4 v5, s[44:47], s11 offen offset:3072 lds
  s_xor_b32 s8, s25, 1
  s_lshl_b32 s12, s8, 7
  s_add_u32 s12, s12, s37
  s_add_u32 m0, s32, 65536
  s_nop 0
  buffer_load_dwordx4 v6, s[40:43], s12 offen offset:0 lds
  buffer_load_dwordx4 v7, s[40:43], s12 offen offset:1024 lds
  s_mov_b64 exec, 0
  s_cmp_eq_u32 s20, 0
  s_cbranch_scc1 L_pad_50
  s_cmp_eq_u32 s20, 1
  s_cbranch_scc1 L_pad_51
  s_cmp_eq_u32 s20, 2
  s_cbranch_scc1 L_pad_52
  s_cmp_eq_u32 s20, 3
  s_cbranch_scc1 L_pad_53
  s_cmp_eq_u32 s20, 4
  s_cbranch_scc1 L_pad_54
  s_cmp_eq_u32 s20, 5
  s_cbranch_scc1 L_pad_55
  s_cmp_eq_u32 s20, 6
  s_cbranch_scc1 L_pad_56
  s_cmp_eq_u32 s20, 7
  s_cbranch_scc1 L_backA
L_backA:
  s_mov_b64 exec, -1
  s_mov_b64 exec, 0
  s_cmp_eq_u32 s20, 0
  s_cbranch_scc1 L_pad_57
  s_cmp_eq_u32 s20, 1
  s_cbranch_scc1 L_pad_58
  s_cmp_eq_u32 s20, 2
  s_cbranch_scc1 L_pad_59
  s_cmp_eq_u32 s20, 3
  s_cbranch_scc1 L_pad_60
  s_cmp_eq_u32 s20, 4
  s_cbranch_scc1 L_pad_61
  s_cmp_eq_u32 s20, 5
  s_cbranch_scc1 L_pad_62
  s_cmp_eq_u32 s20, 6
  s_cbranch_scc1 L_pad_63
  s_cmp_eq_u32 s20, 7
  s_cbranch_scc1 L_pad_64
L_backB:
  s_mov_b64 exec, -1
  s_waitcnt vmcnt(6)
  s_barrier
  ds_read_b128 v[24:27], v10 offset:0
  ds_read_b64_tr_b16 v[16:17], v8 offset:0
  ds_read_b64_tr_b16 v[18:19], v8 offset:512
  ds_read_b128 v[28:31], v10 offset:4096
  ds_read_b64_tr_b16 v[20:21], v9 offset:0
  ds_read_b64_tr_b16 v[22:23], v9 offset:512
  s_waitcnt lgkmcnt(3)
  v_mfma_f32_32x32x16_bf16 v[48:63], v[16:19], v[24:27], 0
  ds_read_b128 v[40:43], v11 offset:0
  ds_read_b64_tr_b16 v[32:33], v8 offset:2048
  s_xor_b32 s8, s25, 2
  s_mul_i32 s11, s8, 229376
  s_add_u32 s11, s11, s36
  s_add_u32 m0, s33, 114688
  s_nop 0
  buffer_load_dwordx4 v2, s[44:47], s11 offen offset:0 lds
  s_waitcnt lgkmcnt(4)
  v_mfma_f32_32x32x16_bf16 v[80:95], v[16:19], v[28:31], 0
  ds_read_b64_tr_b16 v[34:35], v8 offset:2560
  ds_read_b128 v[44:47], v11 offset:4096
  s_waitcnt lgkmcnt(4)
  v_mfma_f32_32x32x16_bf16 v[64:79], v[20:23], v[24:27], 0
  ds_read_b64_tr_b16 v[36:37], v9 offset:2048
  ds_read_b64_tr_b16 v[38:39], v9 offset:2560
  buffer_load_dwordx4 v3, s[44:47], s11 offen offset:1024 lds
  v_mfma_f32_32x32x16_bf16 v[96:111], v[20:23], v[28:31], 0
  s_waitcnt lgkmcnt(3)
  v_mfma_f32_32x32x16_bf16 v[48:63], v[32:35], v[40:43], v[48:63]
  ds_read_b128 v[24:27], v12 offset:0
  ds_read_b64_tr_b16 v[16:17], v8 offset:4096
  buffer_load_dwordx4 v4, s[44:47], s11 offen offset:2048 lds
  s_waitcnt lgkmcnt(4)
  v_mfma_f32_32x32x16_bf16 v[80:95], v[32:35], v[44:47], v[80:95]
  ds_read_b64_tr_b16 v[18:19], v8 offset:4608
  ds_read_b128 v[28:31], v12 offset:4096
  s_waitcnt lgkmcnt(4)
  v_mfma_f32_32x32x16_bf16 v[64:79], v[36:39], v[40:43], v[64:79]
  ds_read_b64_tr_b16 v[20:21], v9 offset:4096
  ds_read_b64_tr_b16 v[22:23], v9 offset:4608
  buffer_load_dwordx4 v5, s[44:47], s11 offen offset:3072 lds
  ds_read_b128 v[112:115], v15 offset:0
  v_mfma_f32_32x32x16_bf16 v[96:111], v[36:39], v[44:47], v[96:111]
  s_waitcnt lgkmcnt(4)
  v_mfma_f32_32x32x16_bf16 v[48:63], v[16:19], v[24:27], v[48:63]
  ds_read_b128 v[40:43], v13 offset:0
  ds_read_b64_tr_b16 v[32:33], v8 offset:6144
  s_xor_b32 s8, s25, 2
  s_lshl_b32 s12, s8, 7
  s_add_u32 s12, s12, s37
  s_add_u32 m0, s32, 114688
  s_nop 0
  buffer_load_dwordx4 v6, s[40:43], s12 offen offset:0 lds
  s_waitcnt lgkmcnt(2)
  v_lshlrev_b32 v118, 16, v112
  v_and_b32 v119, 0xffff0000, v112
  v_mul_f32 v126, v118, v118
  v_mfma_f32_32x32x16_bf16 v[80:95], v[16:19], v[28:31], v[80:95]
  ds_read_b64_tr_b16 v[34:35], v8 offset:6656
  ds_read_b128 v[44:47], v13 offset:4096
  v_mul_f32 v127, v119, v119
L_pad_50:
  s_cbranch_execz L_backA
  v_lshlrev_b32 v120, 16, v113
  v_and_b32 v121, 0xffff0000, v113
  v_mfma_f32_32x32x16_bf16 v[64:79], v[20:23], v[24:27], v[64:79]
  ds_read_b64_tr_b16 v[36:37], v9 offset:6144
  ds_read_b64_tr_b16 v[38:39], v9 offset:6656
  buffer_load_dwordx4 v7, s[40:43], s12 offen offset:1024 lds
  v_fmac_f32 v126, v120, v120
  v_fmac_f32 v127, v121, v121
  v_lshlrev_b32 v122, 16, v114
  v_mfma_f32_32x32x16_bf16 v[96:111], v[20:23], v[28:31], v[96:111]
  s_waitcnt lgkmcnt(3)
  v_mfma_f32_32x32x16_bf16 v[48:63], v[32:35], v[40:43], v[48:63]
  s_waitcnt lgkmcnt(0)
  s_waitcnt vmcnt(6)
  s_barrier
  ds_read_b128 v[24:27], v10 offset:49152
  ds_read_b64_tr_b16 v[16:17], v8 offset:49152
  ds_read_b64_tr_b16 v[18:19], v8 offset:49664
  v_and_b32 v123, 0xffff0000, v114
  v_fmac_f32 v126, v122, v122
  v_fmac_f32 v127, v123, v123
  v_mfma_f32_32x32x16_bf16 v[80:95], v[32:35], v[44:47], v[80:95]
  ds_read_b128 v[28:31], v10 offset:53248
  ds_read_b64_tr_b16 v[20:21], v9 offset:49152
  ds_read_b64_tr_b16 v[22:23], v9 offset:49664
  v_lshlrev_b32 v124, 16, v115
  v_and_b32 v125, 0xffff0000, v115
  v_fmac_f32 v126, v124, v124
  v_mfma_f32_32x32x16_bf16 v[64:79], v[36:39], v[40:43], v[64:79]
  v_fmac_f32 v127, v125, v125
  v_mfma_f32_32x32x16_bf16 v[96:111], v[36:39], v[44:47], v[96:111]
  s_waitcnt lgkmcnt(3)
  v_mfma_f32_32x32x16_bf16 v[48:63], v[16:19], v[24:27], v[48:63]
  ds_read_b128 v[40:43], v11 offset:49152
  ds_read_b64_tr_b16 v[32:33], v8 offset:51200
  s_xor_b32 s8, s25, 3
  s_mul_i32 s11, s8, 229376
  s_add_u32 s11, s11, s36
  s_add_u32 m0, s33, 16384
  s_nop 0
  buffer_load_dwordx4 v2, s[44:47], s11 offen offset:0 lds
  s_waitcnt lgkmcnt(4)
  v_mfma_f32_32x32x16_bf16 v[80:95], v[16:19], v[28:31], v[80:95]
  ds_read_b64_tr_b16 v[34:35], v8 offset:51712
  ds_read_b128 v[44:47], v11 offset:53248
  s_waitcnt lgkmcnt(4)
  v_mfma_f32_32x32x16_bf16 v[64:79], v[20:23], v[24:27], v[64:79]
  ds_read_b64_tr_b16 v[36:37], v9 offset:51200
  ds_read_b64_tr_b16 v[38:39], v9 offset:51712
  buffer_load_dwordx4 v3, s[44:47], s11 offen offset:1024 lds
  v_mfma_f32_32x32x16_bf16 v[96:111], v[20:23], v[28:31], v[96:111]
  s_waitcnt lgkmcnt(3)
  v_mfma_f32_32x32x16_bf16 v[48:63], v[32:35], v[40:43], v[48:63]
  ds_read_b128 v[24:27], v12 offset:49152
  ds_read_b64_tr_b16 v[16:17], v8 offset:53248
  buffer_load_dwordx4 v4, s[44:47], s11 offen offset:2048 lds
  s_waitcnt lgkmcnt(4)
  v_mfma_f32_32x32x16_bf16 v[80:95], v[32:35], v[44:47], v[80:95]
  ds_read_b64_tr_b16 v[18:19], v8 offset:53760
  ds_read_b128 v[28:31], v12 offset:53248
  s_waitcnt lgkmcnt(4)
  v_mfma_f32_32x32x16_bf16 v[64:79], v[36:39], v[40:43], v[64:79]
  ds_read_b64_tr_b16 v[20:21], v9 offset:53248
  ds_read_b64_tr_b16 v[22:23], v9 offset:53760
  buffer_load_dwordx4 v5, s[44:47], s11 offen offset:3072 lds
  ds_read_b128 v[112:115], v15 offset:49152
  v_mfma_f32_32x32x16_bf16 v[96:111], v[36:39], v[44:47], v[96:111]
  s_waitcnt lgkmcnt(4)
  v_mfma_f32_32x32x16_bf16 v[48:63], v[16:19], v[24:27], v[48:63]
  ds_read_b128 v[40:43], v13 offset:49152
  ds_read_b64_tr_b16 v[32:33], v8 offset:55296
  s_xor_b32 s8, s25, 3
  s_lshl_b32 s12, s8, 7
  s_add_u32 s12, s12, s37
  s_add_u32 m0, s32, 16384
  s_nop 0
  buffer_load_dwordx4 v6, s[40:43], s12 offen offset:0 lds
  s_waitcnt lgkmcnt(2)
  v_lshlrev_b32 v116, 16, v112
  v_and_b32 v117, 0xffff0000, v112
  v_add_f32 v118, v118, v116
  v_mfma_f32_32x32x16_bf16 v[80:95], v[16:19], v[28:31], v[80:95]
  ds_read_b64_tr_b16 v[34:35], v8 offset:55808
  ds_read_b128 v[44:47], v13 offset:53248
  v_add_f32 v119, v119, v117
  v_fmac_f32 v126, v116, v116
  v_fmac_f32 v127, v117, v117
  v_mfma_f32_32x32x16_bf16 v[64:79], v[20:23], v[24:27], v[64:79]
  ds_read_b64_tr_b16 v[36:37], v9 offset:55296
  ds_read_b64_tr_b16 v[38:39], v9 offset:55808
  buffer_load_dwordx4 v7, s[40:43], s12 offen offset:1024 lds
  v_lshlrev_b32 v116, 16, v113
  v_and_b32 v117, 0xffff0000, v113
  v_add_f32 v120, v120, v116
  v_mfma_f32_32x32x16_bf16 v[96:111], v[20:23], v[28:31], v[96:111]
  v_add_u32 v8, 98304, v8
  v_add_u32 v9, 98304, v9
  v_add_u32 v10, 98304, v10
  v_add_u32 v11, 98304, v11
  v_add_u32 v12, 98304, v12
  v_add_u32 v13, 98304, v13
  v_add_f32 v121, v121, v117
  v_fmac_f32 v126, v116, v116
  v_fmac_f32 v127, v117, v117
  s_waitcnt lgkmcnt(3)
  v_mfma_f32_32x32x16_bf16 v[48:63], v[32:35], v[40:43], v[48:63]
  s_waitcnt lgkmcnt(0)
  s_waitcnt vmcnt(6)
  s_barrier
  ds_read_b128 v[24:27], v10 offset:0
  ds_read_b64_tr_b16 v[16:17], v8 offset:0
  ds_read_b64_tr_b16 v[18:19], v8 offset:512
  v_lshlrev_b32 v116, 16, v114
  v_and_b32 v117, 0xffff0000, v114
  v_add_f32 v122, v122, v116
  v_mfma_f32_32x32x16_bf16 v[80:95], v[32:35], v[44:47], v[80:95]
  ds_read_b128 v[28:31], v10 offset:4096
  ds_read_b64_tr_b16 v[20:21], v9 offset:0
  ds_read_b64_tr_b16 v[22:23], v9 offset:512
  v_add_f32 v123, v123, v117
  v_fmac_f32 v126, v116, v116
  v_fmac_f32 v127, v117, v117
  v_mfma_f32_32x32x16_bf16 v[64:79], v[36:39], v[40:43], v[64:79]
  v_lshlrev_b32 v116, 16, v115
  v_and_b32 v117, 0xffff0000, v115
  v_add_f32 v124, v124, v116
  v_mfma_f32_32x32x16_bf16 v[96:111], v[36:39], v[44:47], v[96:111]
  v_add_f32 v125, v125, v117
  v_fmac_f32 v126, v116, v116
  v_fmac_f32 v127, v117, v117
  s_waitcnt lgkmcnt(3)
  v_mfma_f32_32x32x16_bf16 v[48:63], v[16:19], v[24:27], v[48:63]
  ds_read_b128 v[40:43], v11 offset:0
  ds_read_b64_tr_b16 v[32:33], v8 offset:2048
  s_xor_b32 s8, s26, 4
  s_mul_i32 s11, s8, 229376
  s_add_u32 s11, s11, s36
  s_add_u32 m0, s33, 65536
  s_nop 0
  buffer_load_dwordx4 v2, s[44:47], s11 offen offset:0 lds
  s_waitcnt lgkmcnt(4)
  v_mfma_f32_32x32x16_bf16 v[80:95], v[16:19], v[28:31], v[80:95]
  ds_read_b64_tr_b16 v[34:35], v8 offset:2560
  ds_read_b128 v[44:47], v11 offset:4096
  s_waitcnt lgkmcnt(4)
  v_mfma_f32_32x32x16_bf16 v[64:79], v[20:23], v[24:27], v[64:79]
  ds_read_b64_tr_b16 v[36:37], v9 offset:2048
  ds_read_b64_tr_b16 v[38:39], v9 offset:2560
  buffer_load_dwordx4 v3, s[44:47], s11 offen offset:1024 lds
  v_mfma_f32_32x32x16_bf16 v[96:111], v[20:23], v[28:31], v[96:111]
  s_waitcnt lgkmcnt(3)
  v_mfma_f32_32x32x16_bf16 v[48:63], v[32:35], v[40:43], v[48:63]
  ds_read_b128 v[24:27], v12 offset:0
  ds_read_b64_tr_b16 v[16:17], v8 offset:4096
  buffer_load_dwordx4 v4, s[44:47], s11 offen offset:2048 lds
  s_waitcnt lgkmcnt(4)
  v_mfma_f32_32x32x16_bf16 v[80:95], v[32:35], v[44:47], v[80:95]
  ds_read_b64_tr_b16 v[18:19], v8 offset:4608
  ds_read_b128 v[28:31], v12 offset:4096
  s_waitcnt lgkmcnt(4)
  v_mfma_f32_32x32x16_bf16 v[64:79], v[36:39], v[40:43], v[64:79]
  ds_read_b64_tr_b16 v[20:21], v9 offset:4096
  ds_read_b64_tr_b16 v[22:23], v9 offset:4608
  buffer_load_dwordx4 v5, s[44:47], s11 offen offset:3072 lds
  v_add_u32 v116, 98304, v15
  ds_read_b128 v[112:115], v116
L_pad_51:
  s_cbranch_execz L_backA
  buffer_load_dword v128, v129, s[60:63], 0 offen offset:0 sc1
  v_mfma_f32_32x32x16_bf16 v[96:111], v[36:39], v[44:47], v[96:111]
  s_waitcnt lgkmcnt(4)
  v_mfma_f32_32x32x16_bf16 v[48:63], v[16:19], v[24:27], v[48:63]
  ds_read_b128 v[40:43], v13 offset:0
  ds_read_b64_tr_b16 v[32:33], v8 offset:6144
  s_xor_b32 s8, s26, 4
  s_lshl_b32 s12, s8, 7
  s_add_u32 s12, s12, s37
  s_add_u32 m0, s32, 65536
  s_nop 0
  buffer_load_dwordx4 v6, s[40:43], s12 offen offset:0 lds
  s_waitcnt lgkmcnt(2)
  v_lshlrev_b32 v116, 16, v112
  v_and_b32 v117, 0xffff0000, v112
  v_add_f32 v118, v118, v116
  v_mfma_f32_32x32x16_bf16 v[80:95], v[16:19], v[28:31], v[80:95]
  ds_read_b64_tr_b16 v[34:35], v8 offset:6656
  ds_read_b128 v[44:47], v13 offset:4096
  v_add_f32 v119, v119, v117
  v_fmac_f32 v126, v116, v116
  v_fmac_f32 v127, v117, v117
  v_mfma_f32_32x32x16_bf16 v[64:79], v[20:23], v[24:27], v[64:79]
  ds_read_b64_tr_b16 v[36:37], v9 offset:6144
  ds_read_b64_tr_b16 v[38:39], v9 offset:6656
  buffer_load_dwordx4 v7, s[40:43], s12 offen offset:1024 lds
  v_lshlrev_b32 v116, 16, v113
  v_and_b32 v117, 0xffff0000, v113
  v_add_f32 v120, v120, v116
  v_mfma_f32_32x32x16_bf16 v[96:111], v[20:23], v[28:31], v[96:111]
  v_subrev_u32 v8, 98304, v8
  v_subrev_u32 v9, 98304, v9
  v_subrev_u32 v10, 98304, v10
  v_subrev_u32 v11, 98304, v11
  v_subrev_u32 v12, 98304, v12
  v_subrev_u32 v13, 98304, v13
  v_add_f32 v121, v121, v117
  v_fmac_f32 v126, v116, v116
  v_fmac_f32 v127, v117, v117
  s_waitcnt lgkmcnt(3)
  v_mfma_f32_32x32x16_bf16 v[48:63], v[32:35], v[40:43], v[48:63]
  s_waitcnt lgkmcnt(0)
  s_waitcnt vmcnt(7)
  s_barrier
  ds_read_b128 v[24:27], v10 offset:0
  ds_read_b64_tr_b16 v[16:17], v8 offset:0
  ds_read_b64_tr_b16 v[18:19], v8 offset:512
  v_lshlrev_b32 v116, 16, v114
  v_and_b32 v117, 0xffff0000, v114
  v_add_f32 v122, v122, v116
  v_mfma_f32_32x32x16_bf16 v[80:95], v[32:35], v[44:47], v[80:95]
  ds_read_b128 v[28:31], v10 offset:4096
  ds_read_b64_tr_b16 v[20:21], v9 offset:0
  ds_read_b64_tr_b16 v[22:23], v9 offset:512
  v_add_f32 v123, v123, v117
  v_fmac_f32 v126, v116, v116
  v_fmac_f32 v127, v117, v117
  s_lshl4_add_u32 s3, s76, 0
  s_add_u32 m0, s91, 0
  s_nop 0
  buffer_load_dwordx4 v0, s[64:67], s3 offen lds
  v_mfma_f32_32x32x16_bf16 v[64:79], v[36:39], v[40:43], v[64:79]
  v_lshlrev_b32 v116, 16, v115
  v_and_b32 v117, 0xffff0000, v115
  v_add_f32 v124, v124, v116
  v_mfma_f32_32x32x16_bf16 v[96:111], v[36:39], v[44:47], v[96:111]
  v_add_f32 v125, v125, v117
  v_fmac_f32 v126, v116, v116
  v_fmac_f32 v127, v117, v117
  s_waitcnt lgkmcnt(3)
  v_mfma_f32_32x32x16_bf16 v[48:63], v[16:19], v[24:27], v[48:63]
  ds_read_b128 v[40:43], v11 offset:0
  ds_read_b64_tr_b16 v[32:33], v8 offset:2048
  s_xor_b32 s8, s26, 5
  s_mul_i32 s11, s8, 229376
  s_add_u32 s11, s11, s36
  s_add_u32 m0, s33, 114688
  s_nop 0
  buffer_load_dwordx4 v2, s[44:47], s11 offen offset:0 lds
  s_waitcnt lgkmcnt(4)
  v_mfma_f32_32x32x16_bf16 v[80:95], v[16:19], v[28:31], v[80:95]
  ds_read_b64_tr_b16 v[34:35], v8 offset:2560
  ds_read_b128 v[44:47], v11 offset:4096
  s_waitcnt lgkmcnt(4)
  v_mfma_f32_32x32x16_bf16 v[64:79], v[20:23], v[24:27], v[64:79]
  ds_read_b64_tr_b16 v[36:37], v9 offset:2048
  ds_read_b64_tr_b16 v[38:39], v9 offset:2560
  buffer_load_dwordx4 v3, s[44:47], s11 offen offset:1024 lds
  v_mfma_f32_32x32x16_bf16 v[96:111], v[20:23], v[28:31], v[96:111]
  s_waitcnt lgkmcnt(3)
  v_mfma_f32_32x32x16_bf16 v[48:63], v[32:35], v[40:43], v[48:63]
  ds_read_b128 v[24:27], v12 offset:0
  ds_read_b64_tr_b16 v[16:17], v8 offset:4096
  buffer_load_dwordx4 v4, s[44:47], s11 offen offset:2048 lds
  s_waitcnt lgkmcnt(4)
  v_mfma_f32_32x32x16_bf16 v[80:95], v[32:35], v[44:47], v[80:95]
  ds_read_b64_tr_b16 v[18:19], v8 offset:4608
  ds_read_b128 v[28:31], v12 offset:4096
  s_waitcnt lgkmcnt(4)
  v_mfma_f32_32x32x16_bf16 v[64:79], v[36:39], v[40:43], v[64:79]
  ds_read_b64_tr_b16 v[20:21], v9 offset:4096
  ds_read_b64_tr_b16 v[22:23], v9 offset:4608
  buffer_load_dwordx4 v5, s[44:47], s11 offen offset:3072 lds
  ds_read_b128 v[112:115], v15 offset:0
  s_waitcnt vmcnt(7)
  v_cmp_ne_u32 vcc, 0, v128
  s_nop 0
  s_cmp_eq_u64 vcc, -1
  s_cbranch_scc1 L_done_4
  s_movk_i32 s18, 4095
L_poll_5:
  s_sleep 2
  buffer_load_dword v128, v129, s[60:63], 0 offen offset:0 sc1
  s_waitcnt vmcnt(0)
  v_cmp_ne_u32 vcc, 0, v128
  s_nop 0
  s_cmp_eq_u64 vcc, -1
  s_cbranch_scc1 L_done_4
  s_sub_u32 s18, s18, 1
  s_cbranch_scc0 L_poll_5
L_done_4:
  v_readfirstlane_b32 s19, v128
  v_mfma_f32_32x32x16_bf16 v[96:111], v[36:39], v[44:47], v[96:111]
  s_waitcnt lgkmcnt(4)
  v_mfma_f32_32x32x16_bf16 v[48:63], v[16:19], v[24:27], v[48:63]
  ds_read_b128 v[40:43], v13 offset:0
  ds_read_b64_tr_b16 v[32:33], v8 offset:6144
  s_xor_b32 s8, s26, 5
  s_lshl_b32 s12, s8, 7
  s_add_u32 s12, s12, s37
  s_add_u32 m0, s32, 114688
  s_nop 0
  buffer_load_dwordx4 v6, s[40:43], s12 offen offset:0 lds
  s_waitcnt lgkmcnt(2)
  v_lshlrev_b32 v116, 16, v112
  v_and_b32 v117, 0xffff0000, v112
  v_add_f32 v118, v118, v116
  v_mfma_f32_32x32x16_bf16 v[80:95], v[16:19], v[28:31], v[80:95]
  ds_read_b64_tr_b16 v[34:35], v8 offset:6656
  ds_read_b128 v[44:47], v13 offset:4096
  v_add_f32 v119, v119, v117
  v_fmac_f32 v126, v116, v116
  v_fmac_f32 v127, v117, v117
  v_mfma_f32_32x32x16_bf16 v[64:79], v[20:23], v[24:27], v[64:79]
  ds_read_b64_tr_b16 v[36:37], v9 offset:6144
  ds_read_b64_tr_b16 v[38:39], v9 offset:6656
  buffer_load_dwordx4 v7, s[40:43], s12 offen offset:1024 lds
  v_lshlrev_b32 v116, 16, v113
  v_and_b32 v117, 0xffff0000, v113
  v_add_f32 v120, v120, v116
  v_mfma_f32_32x32x16_bf16 v[96:111], v[20:23], v[28:31], v[96:111]
  v_add_f32 v121, v121, v117
  v_fmac_f32 v126, v116, v116
  v_fmac_f32 v127, v117, v117
  s_waitcnt lgkmcnt(3)
  v_mfma_f32_32x32x16_bf16 v[48:63], v[32:35], v[40:43], v[48:63]
  s_waitcnt lgkmcnt(0)
  s_waitcnt vmcnt(7)
  s_barrier
  ds_read_b128 v[24:27], v10 offset:49152
  ds_read_b64_tr_b16 v[16:17], v8 offset:49152
  ds_read_b64_tr_b16 v[18:19], v8 offset:49664
  v_lshlrev_b32 v116, 16, v114
  v_and_b32 v117, 0xffff0000, v114
  v_add_f32 v122, v122, v116
  v_mfma_f32_32x32x16_bf16 v[80:95], v[32:35], v[44:47], v[80:95]
  ds_read_b128 v[28:31], v10 offset:53248
  ds_read_b64_tr_b16 v[20:21], v9 offset:49152
  ds_read_b64_tr_b16 v[22:23], v9 offset:49664
  v_add_f32 v123, v123, v117
  v_fmac_f32 v126, v116, v116
  v_fmac_f32 v127, v117, v117
  s_lshl4_add_u32 s3, s76, 458752
  s_add_u32 m0, s91, 8192
  s_nop 0
  buffer_load_dwordx4 v0, s[64:67], s3 offen lds
  v_mfma_f32_32x32x16_bf16 v[64:79], v[36:39], v[40:43], v[64:79]
  v_lshlrev_b32 v116, 16, v115
  v_and_b32 v117, 0xffff0000, v115
  v_add_f32 v124, v124, v116
L_pad_52:
  s_cbranch_execz L_backA
  v_mfma_f32_32x32x16_bf16 v[96:111], v[36:39], v[44:47], v[96:111]
  v_add_f32 v125, v125, v117
  v_fmac_f32 v126, v116, v116
  v_fmac_f32 v127, v117, v117
  s_waitcnt lgkmcnt(3)
  v_mfma_f32_32x32x16_bf16 v[48:63], v[16:19], v[24:27], v[48:63]
  ds_read_b128 v[40:43], v11 offset:49152
  ds_read_b64_tr_b16 v[32:33], v8 offset:51200
  s_xor_b32 s8, s26, 6
  s_mul_i32 s11, s8, 229376
  s_add_u32 s11, s11, s36
  s_add_u32 m0, s33, 16384
  s_nop 0
  buffer_load_dwordx4 v2, s[44:47], s11 offen offset:0 lds
  s_waitcnt lgkmcnt(4)
  v_mfma_f32_32x32x16_bf16 v[80:95], v[16:19], v[28:31], v[80:95]
  ds_read_b64_tr_b16 v[34:35], v8 offset:51712
  ds_read_b128 v[44:47], v11 offset:53248
  s_cmp_lt_u32 s20, 4
  s_cbranch_scc0 L_hi_6
  v_add_f32 v118, v118, v122
  v_add_f32 v119, v119, v123
  v_add_f32 v120, v120, v124
  v_add_f32 v121, v121, v125
  v_add_f32 v127, v126, v127
  v_add_f32 v118, v118, v120
  v_add_f32 v119, v119, v121
  v_add_f32 v126, v118, v119
  s_add_u32 s9, s24, 3
  s_and_b32 s9, s9, 3
  s_xor_b32 s9, s9, s30
  s_xor_b32 s9, s9, 1
  s_lshl2_add_u32 s9, s35, s9
  s_lshl2_add_u32 s9, s9, s90
  s_lshl_b32 s9, s9, 7
  s_and_b32 s10, s25, 4
  s_lshl4_add_u32 s9, s10, s9
  s_add_u32 s9, s9, 12582912
  s_cmp_gt_u32 s24, 4
  s_cselect_b32 s9, 2130706432, s9
  s_branch L_jn_7
L_hi_6:
  s_nop 1
  v_permlane32_swap_b32 v118, v122
  v_permlane32_swap_b32 v119, v123
  v_permlane32_swap_b32 v120, v124
  v_permlane32_swap_b32 v121, v125
  v_add_f32 v118, v118, v122
  v_add_f32 v119, v119, v123
  v_add_f32 v120, v120, v124
  v_add_f32 v121, v121, v125
  s_and_b32 s9, s23, 2
  s_lshl2_add_u32 s9, s34, s9
  s_lshr_b32 s10, s31, 1
  s_add_u32 s9, s9, s10
  s_lshl2_add_u32 s9, s9, s90
  s_lshr_b32 s10, s25, 2
  s_lshl1_add_u32 s9, s9, s10
  s_and_b32 s10, s23, 1
  s_lshl1_add_u32 s9, s9, s10
  s_lshl_b32 s9, s9, 7
  s_add_u32 s9, s9, 12713984
  v_permlane16_swap_b32 v118, v120
  v_permlane16_swap_b32 v119, v121
  v_and_b32 v112, 3, v1
  v_lshlrev_b32 v112, 5, v112
  v_add_f32 v118, v118, v120
  v_add_f32 v119, v119, v121
L_jn_7:
  s_nop 1
  s_waitcnt lgkmcnt(4)
  v_mfma_f32_32x32x16_bf16 v[64:79], v[20:23], v[24:27], v[64:79]
  ds_read_b64_tr_b16 v[36:37], v9 offset:51200
  ds_read_b64_tr_b16 v[38:39], v9 offset:51712
  buffer_load_dwordx4 v3, s[44:47], s11 offen offset:1024 lds
  v_mfma_f32_32x32x16_bf16 v[96:111], v[20:23], v[28:31], v[96:111]
  s_cmp_lt_u32 s20, 4
  s_cbranch_scc0 L_hi_8
  v_add_f32_dpp v126, v126, v126 quad_perm:[1,0,3,2] row_mask:0xf bank_mask:0xf
  v_add_f32_dpp v127, v127, v127 quad_perm:[1,0,3,2] row_mask:0xf bank_mask:0xf
  s_nop 0
  v_add_f32_dpp v126, v126, v126 quad_perm:[2,3,0,1] row_mask:0xf bank_mask:0xf
  v_add_f32_dpp v127, v127, v127 quad_perm:[2,3,0,1] row_mask:0xf bank_mask:0xf
  s_nop 0
  v_add_f32_dpp v126, v126, v126 row_half_mirror row_mask:0xf bank_mask:0xf
  v_add_f32_dpp v127, v127, v127 row_half_mirror row_mask:0xf bank_mask:0xf
  s_branch L_jn_9
L_hi_8:
  s_nop 1
  v_add_f32_dpp v118, v118, v118 row_ror:4 row_mask:0xf bank_mask:0xf
  v_add_f32_dpp v119, v119, v119 row_ror:4 row_mask:0xf bank_mask:0xf
  v_lshrrev_b32 v113, 4, v1
  v_add_f32_dpp v118, v118, v118 row_ror:8 row_mask:0xf bank_mask:0xf
  v_add_f32_dpp v119, v119, v119 row_ror:8 row_mask:0xf bank_mask:0xf
  v_lshl_add_u32 v112, v113, 3, v112
  v_cvt_pk_bf16_f32 v120, v118, v119
  v_and_b32 v121, 0xffff0000, v120
  v_lshlrev_b32 v120, 16, v120
  v_sub_f32 v118, v118, v120
  v_sub_f32 v119, v119, v121
  v_cvt_pk_bf16_f32 v118, v120, v118
  v_cvt_pk_bf16_f32 v119, v121, v119
L_jn_9:
  s_nop 1
  s_waitcnt lgkmcnt(3)
  v_mfma_f32_32x32x16_bf16 v[48:63], v[32:35], v[40:43], v[48:63]
  ds_read_b128 v[24:27], v12 offset:49152
  ds_read_b64_tr_b16 v[16:17], v8 offset:53248
  buffer_load_dwordx4 v4, s[44:47], s11 offen offset:2048 lds
  s_waitcnt lgkmcnt(4)
  v_mfma_f32_32x32x16_bf16 v[80:95], v[32:35], v[44:47], v[80:95]
  ds_read_b64_tr_b16 v[18:19], v8 offset:53760
  ds_read_b128 v[28:31], v12 offset:53248
  s_cmp_lt_u32 s20, 4
  s_cbranch_scc0 L_hi_10
  s_mov_b32 exec_lo, 0x01010101
  s_mov_b32 exec_hi, 0x01010101
  buffer_store_dwordx2 v[126:127], v1, s[48:51], s9 offen sc1
  s_mov_b64 exec, -1
  s_branch L_jn_11
L_hi_10:
  s_nop 1
  s_mov_b32 exec_lo, 0x000f000f
  s_mov_b32 exec_hi, 0x000f000f
  buffer_store_dwordx2 v[118:119], v112, s[48:51], s9 offen sc1
  s_mov_b64 exec, -1
L_jn_11:
  s_nop 1
  s_waitcnt lgkmcnt(4)
  v_mfma_f32_32x32x16_bf16 v[64:79], v[36:39], v[40:43], v[64:79]
  ds_read_b64_tr_b16 v[20:21], v9 offset:53248
  ds_read_b64_tr_b16 v[22:23], v9 offset:53760
  buffer_load_dwordx4 v5, s[44:47], s11 offen offset:3072 lds
  v_mfma_f32_32x32x16_bf16 v[96:111], v[36:39], v[44:47], v[96:111]
  s_waitcnt lgkmcnt(3)
  v_mfma_f32_32x32x16_bf16 v[48:63], v[16:19], v[24:27], v[48:63]
  ds_read_b128 v[40:43], v13 offset:49152
  ds_read_b64_tr_b16 v[32:33], v8 offset:55296
  s_xor_b32 s8, s26, 6
  s_lshl_b32 s12, s8, 7
  s_add_u32 s12, s12, s37
  s_add_u32 m0, s32, 16384
  s_nop 0
  buffer_load_dwordx4 v6, s[40:43], s12 offen offset:0 lds
  s_waitcnt lgkmcnt(4)
  v_mfma_f32_32x32x16_bf16 v[80:95], v[16:19], v[28:31], v[80:95]
  ds_read_b64_tr_b16 v[34:35], v8 offset:55808
  ds_read_b128 v[44:47], v13 offset:53248
  s_waitcnt lgkmcnt(4)
  v_mfma_f32_32x32x16_bf16 v[64:79], v[20:23], v[24:27], v[64:79]
  ds_read_b64_tr_b16 v[36:37], v9 offset:55296
  ds_read_b64_tr_b16 v[38:39], v9 offset:55808
  buffer_load_dwordx4 v7, s[40:43], s12 offen offset:1024 lds
  v_mfma_f32_32x32x16_bf16 v[96:111], v[20:23], v[28:31], v[96:111]
  v_add_u32 v8, 98304, v8
  v_add_u32 v9, 98304, v9
  v_add_u32 v10, 98304, v10
  v_add_u32 v11, 98304, v11
  v_add_u32 v12, 98304, v12
  v_add_u32 v13, 98304, v13
  s_waitcnt lgkmcnt(3)
  v_mfma_f32_32x32x16_bf16 v[48:63], v[32:35], v[40:43], v[48:63]
  s_waitcnt lgkmcnt(0)
  s_waitcnt vmcnt(8)
  s_barrier
  ds_read_b128 v[24:27], v10 offset:0
  ds_read_b64_tr_b16 v[16:17], v8 offset:0
  ds_read_b64_tr_b16 v[18:19], v8 offset:512
  v_mfma_f32_32x32x16_bf16 v[80:95], v[32:35], v[44:47], v[80:95]
  ds_read_b128 v[28:31], v10 offset:4096
  ds_read_b64_tr_b16 v[20:21], v9 offset:0
  ds_read_b64_tr_b16 v[22:23], v9 offset:512
  v_mfma_f32_32x32x16_bf16 v[64:79], v[36:39], v[40:43], v[64:79]
  v_mfma_f32_32x32x16_bf16 v[96:111], v[36:39], v[44:47], v[96:111]
  s_waitcnt lgkmcnt(3)
  v_mfma_f32_32x32x16_bf16 v[48:63], v[16:19], v[24:27], v[48:63]
  ds_read_b128 v[40:43], v11 offset:0
  ds_read_b64_tr_b16 v[32:33], v8 offset:2048
  s_xor_b32 s8, s26, 7
  s_mul_i32 s11, s8, 229376
  s_add_u32 s11, s11, s36
  s_add_u32 m0, s33, 65536
  s_nop 0
  buffer_load_dwordx4 v2, s[44:47], s11 offen offset:0 lds
  s_waitcnt lgkmcnt(4)
  v_mfma_f32_32x32x16_bf16 v[80:95], v[16:19], v[28:31], v[80:95]
  ds_read_b64_tr_b16 v[34:35], v8 offset:2560
  ds_read_b128 v[44:47], v11 offset:4096
L_pad_53:
  s_cbranch_execz L_backA
  s_waitcnt lgkmcnt(4)
  v_mfma_f32_32x32x16_bf16 v[64:79], v[20:23], v[24:27], v[64:79]
  ds_read_b64_tr_b16 v[36:37], v9 offset:2048
  ds_read_b64_tr_b16 v[38:39], v9 offset:2560
  buffer_load_dwordx4 v3, s[44:47], s11 offen offset:1024 lds
  v_mfma_f32_32x32x16_bf16 v[96:111], v[20:23], v[28:31], v[96:111]
  s_waitcnt lgkmcnt(3)
  v_mfma_f32_32x32x16_bf16 v[48:63], v[32:35], v[40:43], v[48:63]
  ds_read_b128 v[24:27], v12 offset:0
  ds_read_b64_tr_b16 v[16:17], v8 offset:4096
  buffer_load_dwordx4 v4, s[44:47], s11 offen offset:2048 lds
  s_waitcnt lgkmcnt(4)
  v_mfma_f32_32x32x16_bf16 v[80:95], v[32:35], v[44:47], v[80:95]
  ds_read_b64_tr_b16 v[18:19], v8 offset:4608
  ds_read_b128 v[28:31], v12 offset:4096
  s_waitcnt lgkmcnt(4)
  v_mfma_f32_32x32x16_bf16 v[64:79], v[36:39], v[40:43], v[64:79]
  ds_read_b64_tr_b16 v[20:21], v9 offset:4096
  ds_read_b64_tr_b16 v[22:23], v9 offset:4608
  buffer_load_dwordx4 v5, s[44:47], s11 offen offset:3072 lds
  v_mfma_f32_32x32x16_bf16 v[96:111], v[36:39], v[44:47], v[96:111]
  s_waitcnt lgkmcnt(3)
  v_mfma_f32_32x32x16_bf16 v[48:63], v[16:19], v[24:27], v[48:63]
  ds_read_b128 v[40:43], v13 offset:0
  ds_read_b64_tr_b16 v[32:33], v8 offset:6144
  s_xor_b32 s8, s26, 7
  s_lshl_b32 s12, s8, 7
  s_add_u32 s12, s12, s37
  s_add_u32 m0, s32, 65536
  s_nop 0
  buffer_load_dwordx4 v6, s[40:43], s12 offen offset:0 lds
  s_waitcnt lgkmcnt(4)
  v_mfma_f32_32x32x16_bf16 v[80:95], v[16:19], v[28:31], v[80:95]
  ds_read_b64_tr_b16 v[34:35], v8 offset:6656
  ds_read_b128 v[44:47], v13 offset:4096
  s_waitcnt lgkmcnt(4)
  v_mfma_f32_32x32x16_bf16 v[64:79], v[20:23], v[24:27], v[64:79]
  ds_read_b64_tr_b16 v[36:37], v9 offset:6144
  ds_read_b64_tr_b16 v[38:39], v9 offset:6656
  buffer_load_dwordx4 v7, s[40:43], s12 offen offset:1024 lds
  v_mfma_f32_32x32x16_bf16 v[96:111], v[20:23], v[28:31], v[96:111]
  v_subrev_u32 v8, 98304, v8
  v_subrev_u32 v9, 98304, v9
  v_subrev_u32 v10, 98304, v10
  v_subrev_u32 v11, 98304, v11
  v_subrev_u32 v12, 98304, v12
  v_subrev_u32 v13, 98304, v13
  s_waitcnt lgkmcnt(3)
  v_mfma_f32_32x32x16_bf16 v[48:63], v[32:35], v[40:43], v[48:63]
  s_waitcnt lgkmcnt(0)
  s_waitcnt vmcnt(6)
  s_barrier
  ds_read_b128 v[24:27], v10 offset:0
  ds_read_b64_tr_b16 v[16:17], v8 offset:0
  ds_read_b64_tr_b16 v[18:19], v8 offset:512
  v_mfma_f32_32x32x16_bf16 v[80:95], v[32:35], v[44:47], v[80:95]
  ds_read_b128 v[28:31], v10 offset:4096
  ds_read_b64_tr_b16 v[20:21], v9 offset:0
  ds_read_b64_tr_b16 v[22:23], v9 offset:512
  s_lshl1_add_u32 s13, s87, s29
  s_lshl_b32 s13, s13, 12
  v_max_i32 v140, 0, v142
  v_lshlrev_b32 v140, 1, v140
  s_lshl3_add_u32 s14, s87, s20
  s_lshl_b32 s14, s14, 10
  buffer_load_dwordx4 v[208:211], v14, s[52:55], s14 offen
  buffer_load_dwordx2 v[212:213], v14, s[52:55], s14 offen offset:16
  buffer_load_ushort v140, v140, s[52:55], s13 offen
  v_mfma_f32_32x32x16_bf16 v[64:79], v[36:39], v[40:43], v[64:79]
  s_lshl1_add_u32 s4, s35, s27
  s_lshl_b32 s4, s4, 10
  s_add_u32 s4, s4, 12582912
  s_lshl1_add_u32 s5, s34, s28
  s_lshl1_add_u32 s5, s5, s29
  s_lshl_b32 s5, s5, 11
  s_add_u32 s5, s5, 12713984
  v_and_b32 v4, 32, v1
  v_lshl_add_u32 v4, v4, 3, v129
  buffer_store_dwordx4 v[144:147], v148, s[48:51], s7 offen sc1
  v_mfma_f32_32x32x16_bf16 v[96:111], v[36:39], v[44:47], v[96:111]
  s_waitcnt lgkmcnt(3)
  v_mfma_f32_32x32x16_bf16 v[48:63], v[16:19], v[24:27], v[48:63]
  ds_read_b128 v[40:43], v11 offset:0
  ds_read_b64_tr_b16 v[32:33], v8 offset:2048
  s_mov_b32 s37, s19
  v_and_b32 v15, 3, v1
  v_lshlrev_b32 v15, 3, v15
  v_bfe_u32 v15, s19, v15, 8
  s_bfe_u32 s25, s19, 524296
  s_bfe_u32 s26, s19, 524304
  s_bfe_u32 s32, s19, 524312
  s_bfe_u32 s19, s19, 524288
  v_and_b32 v5, 31, v1
  v_lshlrev_b32 v5, 5, v5
  v_add_u32 v5, 12615680, v5
  s_waitcnt lgkmcnt(4)
  v_mfma_f32_32x32x16_bf16 v[80:95], v[16:19], v[28:31], v[80:95]
  ds_read_b64_tr_b16 v[34:35], v8 offset:2560
  ds_read_b128 v[44:47], v11 offset:4096
  s_waitcnt lgkmcnt(4)
  v_mfma_f32_32x32x16_bf16 v[64:79], v[20:23], v[24:27], v[64:79]
  ds_read_b64_tr_b16 v[36:37], v9 offset:2048
  ds_read_b64_tr_b16 v[38:39], v9 offset:2560
  buffer_load_dwordx2 v[120:121], v130, s[48:51], s4 offen offset:0 sc1
  buffer_load_dwordx2 v[122:123], v130, s[48:51], s4 offen offset:64 sc1
  v_mfma_f32_32x32x16_bf16 v[96:111], v[20:23], v[28:31], v[96:111]
  buffer_load_dword v112, v4, s[48:51], s5 offen offset:0 sc1
  buffer_load_dword v116, v4, s[48:51], s5 offen offset:64 sc1
  s_waitcnt lgkmcnt(3)
  v_mfma_f32_32x32x16_bf16 v[48:63], v[32:35], v[40:43], v[48:63]
  ds_read_b128 v[24:27], v12 offset:0
  ds_read_b64_tr_b16 v[16:17], v8 offset:4096
  buffer_load_dword v113, v4, s[48:51], s5 offen offset:512 sc1
  buffer_load_dword v117, v4, s[48:51], s5 offen offset:576 sc1
  s_waitcnt lgkmcnt(4)
  v_mfma_f32_32x32x16_bf16 v[80:95], v[32:35], v[44:47], v[80:95]
  ds_read_b64_tr_b16 v[18:19], v8 offset:4608
  ds_read_b128 v[28:31], v12 offset:4096
  buffer_load_dword v114, v4, s[48:51], s5 offen offset:1024 sc1
  buffer_load_dword v118, v4, s[48:51], s5 offen offset:1088 sc1
  s_waitcnt lgkmcnt(4)
  v_mfma_f32_32x32x16_bf16 v[64:79], v[36:39], v[40:43], v[64:79]
  ds_read_b64_tr_b16 v[20:21], v9 offset:4096
  ds_read_b64_tr_b16 v[22:23], v9 offset:4608
  buffer_load_dword v115, v4, s[48:51], s5 offen offset:1536 sc1
  buffer_load_dword v119, v4, s[48:51], s5 offen offset:1600 sc1
  v_mfma_f32_32x32x16_bf16 v[96:111], v[36:39], v[44:47], v[96:111]
  s_waitcnt lgkmcnt(3)
  v_mfma_f32_32x32x16_bf16 v[48:63], v[16:19], v[24:27], v[48:63]
  ds_read_b128 v[40:43], v13 offset:0
  ds_read_b64_tr_b16 v[32:33], v8 offset:6144
  s_waitcnt lgkmcnt(4)
  v_mfma_f32_32x32x16_bf16 v[80:95], v[16:19], v[28:31], v[80:95]
  ds_read_b64_tr_b16 v[34:35], v8 offset:6656
  ds_read_b128 v[44:47], v13 offset:4096
  s_waitcnt lgkmcnt(4)
  v_mfma_f32_32x32x16_bf16 v[64:79], v[20:23], v[24:27], v[64:79]
  ds_read_b64_tr_b16 v[36:37], v9 offset:6144
  ds_read_b64_tr_b16 v[38:39], v9 offset:6656
  v_mfma_f32_32x32x16_bf16 v[96:111], v[20:23], v[28:31], v[96:111]
  s_waitcnt lgkmcnt(3)
  v_mfma_f32_32x32x16_bf16 v[48:63], v[32:35], v[40:43], v[48:63]
  s_waitcnt lgkmcnt(0)
  s_waitcnt vmcnt(14)
  s_barrier
  ds_read_b128 v[24:27], v10 offset:49152
  ds_read_b64_tr_b16 v[16:17], v8 offset:49152
  ds_read_b64_tr_b16 v[18:19], v8 offset:49664
  s_waitcnt vmcnt(7)
  v_max3_u32 v124, v121, v123, v112
  s_waitcnt vmcnt(3)
  v_max3_u32 v124, v124, v113, v114
  s_waitcnt vmcnt(1)
  v_max3_u32 v124, v124, v115, v116
  v_max3_u32 v124, v124, v117, v118
  s_waitcnt vmcnt(0)
  v_max3_u32 v124, v124, v119, v119
  v_cmp_eq_u32 vcc, -1, v124
  s_nop 0
  s_cmp_eq_u64 vcc, 0
  s_cbranch_scc1 L_done_13
  s_movk_i32 s18, 4095
L_poll_14:
  s_sleep 2
L_pad_54:
  s_cbranch_execz L_backA
  buffer_load_dwordx2 v[120:121], v130, s[48:51], s4 offen offset:0 sc1
  buffer_load_dwordx2 v[122:123], v130, s[48:51], s4 offen offset:64 sc1
  buffer_load_dword v112, v4, s[48:51], s5 offen offset:0 sc1
  buffer_load_dword v116, v4, s[48:51], s5 offen offset:64 sc1
  buffer_load_dword v113, v4, s[48:51], s5 offen offset:512 sc1
  buffer_load_dword v117, v4, s[48:51], s5 offen offset:576 sc1
  buffer_load_dword v114, v4, s[48:51], s5 offen offset:1024 sc1
  buffer_load_dword v118, v4, s[48:51], s5 offen offset:1088 sc1
  buffer_load_dword v115, v4, s[48:51], s5 offen offset:1536 sc1
  buffer_load_dword v119, v4, s[48:51], s5 offen offset:1600 sc1
  s_waitcnt vmcnt(0)
  v_max3_u32 v124, v121, v123, v112
  v_max3_u32 v124, v124, v113, v114
  v_max3_u32 v124, v124, v115, v116
  v_max3_u32 v124, v124, v117, v118
  v_max3_u32 v124, v124, v119, v119
  v_cmp_eq_u32 vcc, -1, v124
  s_nop 0
  s_cmp_eq_u64 vcc, 0
  s_cbranch_scc1 L_done_13
  s_sub_u32 s18, s18, 1
  s_cbranch_scc0 L_poll_14
L_done_13:
  v_mfma_f32_32x32x16_bf16 v[80:95], v[32:35], v[44:47], v[80:95]
  ds_read_b128 v[188:191], v12 offset:49152
  ds_read_b64_tr_b16 v[180:181], v8 offset:53248
  ds_read_b64_tr_b16 v[182:183], v8 offset:53760
  v_add_f32 v120, v120, v122
  v_add_f32 v121, v121, v123
  v_mul_f32 v120, 0xbb000000, v120
  v_mul_f32 v121, 0x3b000000, v121
  v_fma_f32 v121, -v120, v120, v121
  v_max_f32 v121, 0, v121
  v_cvt_pk_bf16_f32 v240, v120, v120
  v_cvt_pk_bf16_f32 v121, v121, v121
  v_and_b32 v121, 0xffff0000, v121
  v_add_f32 v121, 0x3727c5ac, v121
  v_mfma_f32_32x32x16_bf16 v[64:79], v[36:39], v[40:43], v[64:79]
  ds_read_b128 v[144:147], v13 offset:49152
  ds_read_b64_tr_b16 v[248:249], v8 offset:55296
  ds_read_b64_tr_b16 v[250:251], v8 offset:55808
  v_cvt_pk_bf16_f32 v121, v121, v121
  v_and_b32 v121, 0xffff0000, v121
  v_sqrt_f32 v121, v121
  s_nop 0
  v_cvt_pk_bf16_f32 v121, v121, v121
  v_and_b32 v121, 0xffff0000, v121
  v_mfma_f32_32x32x16_bf16 v[96:111], v[36:39], v[44:47], v[96:111]
  ds_read_b128 v[40:43], v11 offset:49152
  ds_read_b64_tr_b16 v[32:33], v8 offset:51200
  ds_read_b64_tr_b16 v[34:35], v8 offset:51712
  v_rcp_f32 v122, v121
  v_mul_f32 v158, v121, v121
  v_mov_b32 v244, v240
  v_mul_f32 v150, 0xc0135761, v122
  v_mul_f32 v154, v122, v122
  s_waitcnt lgkmcnt(9)
  v_mfma_f32_32x32x16_bf16 v[48:63], v[16:19], v[24:27], v[48:63]
  v_permlane32_swap_b32 v240, v244
  v_mul_f32 v154, 0x3d372713, v154
  v_mov_b32 v160, v158
  v_mul_f32 v154, v154, v150
  v_mov_b32 v152, v150
  v_mov_b32 v241, v240
  v_mov_b32 v242, v240
  v_mov_b32 v243, v240
  v_mov_b32 v156, v154
  v_mov_b32 v245, v244
  s_waitcnt lgkmcnt(6)
  v_mfma_f32_32x32x16_bf16 v[48:63], v[180:183], v[188:191], v[48:63]
  ds_read_b64_tr_b16 v[20:21], v9 offset:49152
  ds_read_b64_tr_b16 v[22:23], v9 offset:49664
  s_lshl4_add_u32 s3, s77, 0
  s_add_u32 m0, s91, 16384
  s_nop 0
  buffer_load_dwordx4 v0, s[64:67], s3 offen lds
  s_mul_i32 s14, s29, 24576
  s_lshl_b32 s15, s90, 10
  s_add_u32 s15, s15, s14
  s_add_u32 s15, s15, 114688
  v_add_u32 v6, s15, v14
  ds_write_b128 v6, v[210:213] offset:19680
  v_mov_b32 v246, v244
  v_mov_b32 v247, v244
  v_permlane32_swap_b32 v150, v152
  v_permlane32_swap_b32 v154, v156
  v_permlane32_swap_b32 v158, v160
  s_waitcnt lgkmcnt(6)
  v_mfma_f32_32x32x16_bf16 v[48:63], v[248:251], v[144:147], v[48:63]
  ds_read_b64_tr_b16 v[184:185], v9 offset:53248
  ds_read_b64_tr_b16 v[186:187], v9 offset:53760
  v_alignbit_b32 v214, v209, v208, 16
  v_alignbit_b32 v215, v210, v209, 16
  v_alignbit_b32 v216, v211, v210, 16
  v_alignbit_b32 v217, v212, v211, 16
  ds_write_b128 v6, v[214:217] offset:32
  v_mov_b32 v151, v150
  v_mov_b32 v153, v152
  v_mov_b32 v155, v154
  v_mov_b32 v157, v156
  v_mov_b32 v159, v158
  s_waitcnt lgkmcnt(6)
  v_mfma_f32_32x32x16_bf16 v[48:63], v[32:35], v[40:43], v[48:63]
  ds_read_b64_tr_b16 v[252:253], v9 offset:55296
  ds_read_b64_tr_b16 v[254:255], v9 offset:55808
  s_lshl4_add_u32 s3, s77, 458752
  s_add_u32 m0, s91, 24576
  s_nop 0
  buffer_load_dwordx4 v0, s[64:67], s3 offen lds
  v_mov_b32 v218, v209
  v_mov_b32 v219, v210
  v_mov_b32 v220, v211
  v_mov_b32 v221, v212
  ds_write_b128 v6, v[218:221] offset:4192
  v_mov_b32 v161, v160
  v_mfma_f32_32x32x16_bf16 v[48:63], v[112:115], v[240:243], v[48:63]
  ds_read_b64_tr_b16 v[36:37], v9 offset:51200
  ds_read_b64_tr_b16 v[38:39], v9 offset:51712
  ds_read_b128 v[28:31], v10 offset:53248
  s_lshl1_add_u32 s88, s24, s28
  s_lshl_b32 s3, s89, 9
  s_add_u32 s88, s88, s3
  s_lshl_b32 s88, s88, 6
  v_and_b32 v168, 31, v1
  v_lshrrev_b32 v143, 5, v1
  v_lshlrev_b32 v143, 4, v143
  v_lshl_add_u32 v143, v168, 10, v143
  s_cmp_lt_u32 s20, 4
  s_cbranch_scc1 L_xs_12
  buffer_load_dwordx4 v[168:171], v143, s[40:43], s88 offen offset:0
  buffer_load_dwordx4 v[172:175], v143, s[40:43], s88 offen offset:32
L_xs_12:
  v_alignbit_b32 v222, v210, v209, 16
  v_alignbit_b32 v223, v211, v210, 16
  v_alignbit_b32 v224, v212, v211, 16
  v_alignbit_b32 v225, v213, v212, 16
  ds_write_b128 v6, v[222:225] offset:15520
  s_waitcnt lgkmcnt(11)
  v_mfma_f32_32x32x16_bf16 v[64:79], v[20:23], v[24:27], v[64:79]
  ds_read_b128 v[192:195], v12 offset:53248
  s_lshl4_add_u32 s3, s78, 0
  s_add_u32 m0, s91, 32768
  s_nop 0
  buffer_load_dwordx4 v0, s[64:67], s3 offen lds
  s_lshl_b32 s15, s90, 8
  s_add_u32 s15, s15, s14
  s_add_u32 s15, s15, 129024
  v_lshl_add_u32 v7, v1, 2, s15
  v_mov_b32 v226, 0
  ds_write_b32 v7, v226
  s_waitcnt lgkmcnt(10)
  v_mfma_f32_32x32x16_bf16 v[64:79], v[184:187], v[188:191], v[64:79]
  ds_read_b128 v[164:167], v13 offset:53248
  v_pk_mul_f32 v[196:197], v[48:49], v[48:49]
  v_pk_mul_f32 v[198:199], v[50:51], v[50:51]
  v_pk_mul_f32 v[200:201], v[52:53], v[52:53]
  v_pk_mul_f32 v[202:203], v[54:55], v[54:55]
  v_pk_fma_f32 v[196:197], v[196:197], v[154:155], v[150:151]
  v_pk_fma_f32 v[198:199], v[198:199], v[154:155], v[150:151]
  v_pk_fma_f32 v[200:201], v[200:201], v[154:155], v[150:151]
  v_pk_fma_f32 v[202:203], v[202:203], v[154:155], v[150:151]
  v_pk_mul_f32 v[196:197], v[196:197], v[48:49]
  s_waitcnt lgkmcnt(8)
  v_mfma_f32_32x32x16_bf16 v[64:79], v[252:255], v[144:147], v[64:79]
  ds_read_b128 v[44:47], v11 offset:53248
  s_lshl4_add_u32 s3, s78, 458752
  s_add_u32 m0, s91, 40960
  s_nop 0
  buffer_load_dwordx4 v0, s[64:67], s3 offen lds
  v_cmp_le_i32 vcc, 0, v142
  s_nop 1
  v_cndmask_b32 v140, 0, v140, vcc
  ds_write_b16 v141, v140
L_pad_55:
  s_cbranch_execz L_backA
  v_pk_mul_f32 v[198:199], v[198:199], v[50:51]
  v_pk_mul_f32 v[200:201], v[200:201], v[52:53]
  v_pk_mul_f32 v[202:203], v[202:203], v[54:55]
  v_exp_f32 v196, v196
  v_exp_f32 v197, v197
  v_pk_mul_f32 v[48:49], v[48:49], v[56:57]
  v_exp_f32 v198, v198
  v_exp_f32 v199, v199
  v_pk_mul_f32 v[50:51], v[50:51], v[58:59]
  s_waitcnt lgkmcnt(7)
  v_mfma_f32_32x32x16_bf16 v[64:79], v[36:39], v[40:43], v[64:79]
  s_waitcnt lgkmcnt(0)
  s_barrier
  v_exp_f32 v200, v200
  v_exp_f32 v201, v201
  v_pk_mul_f32 v[52:53], v[52:53], v[60:61]
  v_exp_f32 v202, v202
  v_exp_f32 v203, v203
  v_pk_mul_f32 v[54:55], v[54:55], v[62:63]
  v_pk_fma_f32 v[196:197], v[196:197], v[158:159], v[158:159]
  v_pk_fma_f32 v[198:199], v[198:199], v[158:159], v[158:159]
  v_pk_fma_f32 v[200:201], v[200:201], v[158:159], v[158:159]
  v_mfma_f32_32x32x16_bf16 v[64:79], v[116:119], v[240:243], v[64:79]
  s_lshl4_add_u32 s3, s79, 0
  s_add_u32 m0, s91, 49152
  s_nop 0
  buffer_load_dwordx4 v0, s[64:67], s3 offen lds
  buffer_load_dword v176, v5, s[48:51], 0 offen sc1
  v_pk_fma_f32 v[202:203], v[202:203], v[158:159], v[158:159]
  v_rcp_f32 v196, v196
  v_rcp_f32 v197, v197
  v_rcp_f32 v198, v198
  v_rcp_f32 v199, v199
  v_rcp_f32 v200, v200
  v_rcp_f32 v201, v201
  v_rcp_f32 v202, v202
  v_rcp_f32 v203, v203
  v_mfma_f32_32x32x16_bf16 v[80:95], v[16:19], v[28:31], v[80:95]
  s_cmp_lt_u32 s20, 4
  s_cbranch_scc0 L_hi_15
  s_branch L_jn_16
L_hi_15:
  s_nop 1
  s_setprio 1
L_jn_16:
  s_nop 1
  v_pk_mul_f32 v[48:49], v[48:49], v[196:197]
  v_pk_mul_f32 v[50:51], v[50:51], v[198:199]
  v_pk_mul_f32 v[52:53], v[52:53], v[200:201]
  v_pk_mul_f32 v[54:55], v[54:55], v[202:203]
  v_cvt_pk_bf16_f32 v204, v48, v49
  v_cvt_pk_bf16_f32 v205, v50, v51
  v_cvt_pk_bf16_f32 v206, v52, v53
  v_cvt_pk_bf16_f32 v207, v54, v55
  buffer_store_dwordx4 v[204:207], v14, s[48:51], s83 offen offset:0 sc1
  v_mfma_f32_32x32x16_bf16 v[80:95], v[180:183], v[192:195], v[80:95]
  s_lshl4_add_u32 s3, s79, 458752
  s_add_u32 m0, s91, 57344
  s_nop 0
  buffer_load_dwordx4 v0, s[64:67], s3 offen lds
  v_pk_mul_f32 v[228:229], v[64:65], v[64:65]
  v_pk_mul_f32 v[230:231], v[66:67], v[66:67]
  v_pk_mul_f32 v[232:233], v[68:69], v[68:69]
  v_pk_mul_f32 v[234:235], v[70:71], v[70:71]
  v_pk_fma_f32 v[228:229], v[228:229], v[154:155], v[150:151]
  v_pk_fma_f32 v[230:231], v[230:231], v[154:155], v[150:151]
  v_pk_fma_f32 v[232:233], v[232:233], v[154:155], v[150:151]
  v_pk_fma_f32 v[234:235], v[234:235], v[154:155], v[150:151]
  v_pk_mul_f32 v[228:229], v[228:229], v[64:65]
  v_mfma_f32_32x32x16_bf16 v[80:95], v[248:251], v[164:167], v[80:95]
  v_pk_mul_f32 v[230:231], v[230:231], v[66:67]
  v_pk_mul_f32 v[232:233], v[232:233], v[68:69]
  v_pk_mul_f32 v[234:235], v[234:235], v[70:71]
  v_exp_f32 v228, v228
  v_exp_f32 v229, v229
  v_pk_mul_f32 v[64:65], v[64:65], v[72:73]
  v_exp_f32 v230, v230
  v_exp_f32 v231, v231
  v_pk_mul_f32 v[66:67], v[66:67], v[74:75]
  v_mfma_f32_32x32x16_bf16 v[80:95], v[32:35], v[44:47], v[80:95]
  v_exp_f32 v232, v232
  v_exp_f32 v233, v233
  v_pk_mul_f32 v[68:69], v[68:69], v[76:77]
  v_exp_f32 v234, v234
  v_exp_f32 v235, v235
  v_pk_mul_f32 v[70:71], v[70:71], v[78:79]
  v_pk_fma_f32 v[228:229], v[228:229], v[158:159], v[158:159]
  v_pk_fma_f32 v[230:231], v[230:231], v[158:159], v[158:159]
  v_pk_fma_f32 v[232:233], v[232:233], v[158:159], v[158:159]
  v_mfma_f32_32x32x16_bf16 v[80:95], v[112:115], v[244:247], v[80:95]
  v_pk_fma_f32 v[234:235], v[234:235], v[158:159], v[158:159]
  v_rcp_f32 v228, v228
  v_rcp_f32 v229, v229
  v_rcp_f32 v230, v230
  v_rcp_f32 v231, v231
  v_rcp_f32 v232, v232
  v_rcp_f32 v233, v233
  v_rcp_f32 v234, v234
  v_rcp_f32 v235, v235
  v_mfma_f32_32x32x16_bf16 v[96:111], v[20:23], v[28:31], v[96:111]
  s_cmp_lt_u32 s20, 4
  s_cbranch_scc1 L_ks_17
  s_waitcnt vmcnt(2)
  v_cmp_eq_u32 vcc, 1, v176
  s_nop 0
  s_cmp_eq_u64 vcc, -1
  s_cbranch_scc1 L_done_18
  s_movk_i32 s18, 4095
L_poll_19:
  s_sleep 2
  s_waitcnt vmcnt(2)
  buffer_load_dword v176, v5, s[48:51], 0 offen sc1
  s_waitcnt vmcnt(0)
  s_waitcnt vmcnt(2)
  v_cmp_eq_u32 vcc, 1, v176
  s_nop 0
  s_cmp_eq_u64 vcc, -1
  s_cbranch_scc1 L_done_18
  s_sub_u32 s18, s18, 1
  s_cbranch_scc0 L_poll_19
L_done_18:
  s_lshl1_add_u32 s13, s87, s28
  s_lshl_b32 s13, s13, 12
  s_add_u32 s13, s13, 8388608
  s_mul_i32 s14, s28, 24576
  s_add_u32 m0, s14, 124928
  s_nop 0
  buffer_load_dwordx4 v14, s[48:51], s13 offen offset:0 sc1 lds
  buffer_load_dwordx4 v14, s[48:51], s13 offen offset:1024 sc1 lds
  buffer_load_dwordx4 v14, s[48:51], s13 offen offset:2048 sc1 lds
  buffer_load_dwordx4 v14, s[48:51], s13 offen offset:3072 sc1 lds
L_ks_17:
  v_pk_mul_f32 v[64:65], v[64:65], v[228:229]
  v_pk_mul_f32 v[66:67], v[66:67], v[230:231]
  v_pk_mul_f32 v[68:69], v[68:69], v[232:233]
  v_pk_mul_f32 v[70:71], v[70:71], v[234:235]
  v_cvt_pk_bf16_f32 v236, v64, v65
  v_cvt_pk_bf16_f32 v237, v66, v67
  v_cvt_pk_bf16_f32 v238, v68, v69
  v_cvt_pk_bf16_f32 v239, v70, v71
  buffer_store_dwordx4 v[236:239], v14, s[48:51], s83 offen offset:1024 sc1
  v_mfma_f32_32x32x16_bf16 v[96:111], v[184:187], v[192:195], v[96:111]
  v_mfma_f32_32x32x16_bf16 v[96:111], v[252:255], v[164:167], v[96:111]
  v_mfma_f32_32x32x16_bf16 v[96:111], v[36:39], v[44:47], v[96:111]
  v_mfma_f32_32x32x16_bf16 v[96:111], v[116:119], v[244:247], v[96:111]
  v_pk_mul_f32 v[16:17], v[80:81], v[80:81]
  v_pk_mul_f32 v[18:19], v[82:83], v[82:83]
  v_pk_mul_f32 v[20:21], v[84:85], v[84:85]
  v_pk_mul_f32 v[22:23], v[86:87], v[86:87]
  v_pk_fma_f32 v[16:17], v[16:17], v[156:157], v[152:153]
  v_pk_fma_f32 v[18:19], v[18:19], v[156:157], v[152:153]
  v_pk_fma_f32 v[20:21], v[20:21], v[156:157], v[152:153]
  v_pk_fma_f32 v[22:23], v[22:23], v[156:157], v[152:153]
  v_pk_mul_f32 v[16:17], v[16:17], v[80:81]
  v_pk_mul_f32 v[18:19], v[18:19], v[82:83]
  v_pk_mul_f32 v[20:21], v[20:21], v[84:85]
  v_pk_mul_f32 v[22:23], v[22:23], v[86:87]
  v_exp_f32 v16, v16
  v_exp_f32 v17, v17
  v_pk_mul_f32 v[80:81], v[80:81], v[88:89]
  v_exp_f32 v18, v18
  v_exp_f32 v19, v19
  v_pk_mul_f32 v[82:83], v[82:83], v[90:91]
  v_exp_f32 v20, v20
  v_exp_f32 v21, v21
  v_pk_mul_f32 v[84:85], v[84:85], v[92:93]
  v_exp_f32 v22, v22
  v_exp_f32 v23, v23
  v_pk_mul_f32 v[86:87], v[86:87], v[94:95]
  v_pk_fma_f32 v[16:17], v[16:17], v[160:161], v[160:161]
  v_pk_fma_f32 v[18:19], v[18:19], v[160:161], v[160:161]
  v_pk_fma_f32 v[20:21], v[20:21], v[160:161], v[160:161]
  v_pk_fma_f32 v[22:23], v[22:23], v[160:161], v[160:161]
  v_rcp_f32 v16, v16
  v_rcp_f32 v17, v17
  v_rcp_f32 v18, v18
  v_rcp_f32 v19, v19
  v_rcp_f32 v20, v20
  v_rcp_f32 v21, v21
  v_rcp_f32 v22, v22
  v_rcp_f32 v23, v23
L_pad_56:
  s_cbranch_execz L_backA
  v_pk_mul_f32 v[80:81], v[80:81], v[16:17]
  v_pk_mul_f32 v[82:83], v[82:83], v[18:19]
  v_pk_mul_f32 v[84:85], v[84:85], v[20:21]
  v_pk_mul_f32 v[86:87], v[86:87], v[22:23]
  v_cvt_pk_bf16_f32 v24, v80, v81
  v_cvt_pk_bf16_f32 v25, v82, v83
  v_cvt_pk_bf16_f32 v26, v84, v85
  v_cvt_pk_bf16_f32 v27, v86, v87
  v_pk_mul_f32 v[28:29], v[96:97], v[96:97]
  v_pk_mul_f32 v[30:31], v[98:99], v[98:99]
  v_pk_mul_f32 v[32:33], v[100:101], v[100:101]
  v_pk_mul_f32 v[34:35], v[102:103], v[102:103]
  v_pk_fma_f32 v[28:29], v[28:29], v[156:157], v[152:153]
  v_pk_fma_f32 v[30:31], v[30:31], v[156:157], v[152:153]
  v_pk_fma_f32 v[32:33], v[32:33], v[156:157], v[152:153]
  v_pk_fma_f32 v[34:35], v[34:35], v[156:157], v[152:153]
  v_pk_mul_f32 v[28:29], v[28:29], v[96:97]
  v_pk_mul_f32 v[30:31], v[30:31], v[98:99]
  v_pk_mul_f32 v[32:33], v[32:33], v[100:101]
  v_pk_mul_f32 v[34:35], v[34:35], v[102:103]
  v_exp_f32 v28, v28
  v_exp_f32 v29, v29
  v_pk_mul_f32 v[96:97], v[96:97], v[104:105]
  v_exp_f32 v30, v30
  v_exp_f32 v31, v31
  v_pk_mul_f32 v[98:99], v[98:99], v[106:107]
  v_exp_f32 v32, v32
  v_exp_f32 v33, v33
  v_pk_mul_f32 v[100:101], v[100:101], v[108:109]
  v_exp_f32 v34, v34
  v_exp_f32 v35, v35
  v_pk_mul_f32 v[102:103], v[102:103], v[110:111]
  v_pk_fma_f32 v[28:29], v[28:29], v[160:161], v[160:161]
  v_pk_fma_f32 v[30:31], v[30:31], v[160:161], v[160:161]
  v_pk_fma_f32 v[32:33], v[32:33], v[160:161], v[160:161]
  v_pk_fma_f32 v[34:35], v[34:35], v[160:161], v[160:161]
  v_rcp_f32 v28, v28
  v_rcp_f32 v29, v29
  v_rcp_f32 v30, v30
  v_rcp_f32 v31, v31
  v_rcp_f32 v32, v32
  v_rcp_f32 v33, v33
  v_rcp_f32 v34, v34
  v_rcp_f32 v35, v35
  v_pk_mul_f32 v[96:97], v[96:97], v[28:29]
  v_pk_mul_f32 v[98:99], v[98:99], v[30:31]
  v_pk_mul_f32 v[100:101], v[100:101], v[32:33]
  v_pk_mul_f32 v[102:103], v[102:103], v[34:35]
  v_cvt_pk_bf16_f32 v36, v96, v97
  v_cvt_pk_bf16_f32 v37, v98, v99
  v_cvt_pk_bf16_f32 v38, v100, v101
  v_cvt_pk_bf16_f32 v39, v102, v103
  s_waitcnt vmcnt(0)
  v_mov_b32 v140, 1
  s_mov_b64 exec, 1
  buffer_store_dword v140, off, s[48:51], s85 sc1
  s_mov_b64 exec, -1
  buffer_store_dwordx4 v[24:27], v14, s[48:51], s84 offen offset:0 sc1
  buffer_store_dwordx4 v[36:39], v14, s[48:51], s84 offen offset:1024 sc1
  s_waitcnt lgkmcnt(0)
L_t0:
  s_cmp_lt_u32 s20, 4
  s_cbranch_scc1 L_poll
  s_branch L_cv
L_conv:
  s_waitcnt lgkmcnt(15)
  v_mfma_f32_16x16x32_bf16 v[40:43], v[48:51], v[104:107], v[40:43]
  v_mfma_f32_16x16x32_bf16 v[44:47], v[48:51], v[108:111], v[44:47]
  ds_read_b128 v[108:111], v133 offset:64
  v_mfma_f32_16x16x32_bf16 v[36:39], v[48:51], v[100:103], v[36:39]
  s_waitcnt lgkmcnt(15)
  v_mfma_f32_16x16x32_bf16 v[32:35], v[48:51], v[96:99], v[32:35]
  s_waitcnt lgkmcnt(12)
  v_mfma_f32_16x16x32_bf16 v[28:31], v[48:51], v[92:95], v[28:31]
  s_waitcnt lgkmcnt(9)
  v_mfma_f32_16x16x32_bf16 v[24:27], v[48:51], v[88:91], v[24:27]
  s_waitcnt lgkmcnt(6)
  v_mfma_f32_16x16x32_bf16 v[20:23], v[48:51], v[84:87], v[20:23]
  s_waitcnt lgkmcnt(3)
  v_mfma_f32_16x16x32_bf16 v[16:19], v[48:51], v[80:83], v[16:19]
  ds_read_b64 v[48:49], v132 offset:64
  ds_read_b64 v[50:51], v132 offset:72
  v_mfma_f32_16x16x32_bf16 v[44:47], v[52:55], v[104:107], v[44:47]
  ds_read_b128 v[104:107], v133 offset:576
  v_mfma_f32_16x16x32_bf16 v[40:43], v[52:55], v[100:103], v[40:43]
  v_mfma_f32_16x16x32_bf16 v[36:39], v[52:55], v[96:99], v[36:39]
  v_mfma_f32_16x16x32_bf16 v[32:35], v[52:55], v[92:95], v[32:35]
  v_mfma_f32_16x16x32_bf16 v[28:31], v[52:55], v[88:91], v[28:31]
  v_mfma_f32_16x16x32_bf16 v[24:27], v[52:55], v[84:87], v[24:27]
  v_mfma_f32_16x16x32_bf16 v[20:23], v[52:55], v[80:83], v[20:23]
  ds_read_b64 v[52:53], v132 offset:576
  ds_read_b64 v[54:55], v132 offset:584
  v_mfma_f32_16x16x32_bf16 v[44:47], v[56:59], v[100:103], v[44:47]
  ds_read_b128 v[100:103], v133 offset:1088
  v_mfma_f32_16x16x32_bf16 v[40:43], v[56:59], v[96:99], v[40:43]
  v_mfma_f32_16x16x32_bf16 v[36:39], v[56:59], v[92:95], v[36:39]
  v_mfma_f32_16x16x32_bf16 v[32:35], v[56:59], v[88:91], v[32:35]
  v_mfma_f32_16x16x32_bf16 v[28:31], v[56:59], v[84:87], v[28:31]
  v_mfma_f32_16x16x32_bf16 v[24:27], v[56:59], v[80:83], v[24:27]
  ds_read_b64 v[56:57], v132 offset:1088
  ds_read_b64 v[58:59], v132 offset:1096
  v_mfma_f32_16x16x32_bf16 v[44:47], v[60:63], v[96:99], v[44:47]
  ds_read_b128 v[96:99], v133 offset:1600
  v_mfma_f32_16x16x32_bf16 v[40:43], v[60:63], v[92:95], v[40:43]
  v_mfma_f32_16x16x32_bf16 v[36:39], v[60:63], v[88:91], v[36:39]
  v_mfma_f32_16x16x32_bf16 v[32:35], v[60:63], v[84:87], v[32:35]
  v_mfma_f32_16x16x32_bf16 v[28:31], v[60:63], v[80:83], v[28:31]
  ds_read_b64 v[60:61], v132 offset:1600
  ds_read_b64 v[62:63], v132 offset:1608
  v_mfma_f32_16x16x32_bf16 v[44:47], v[64:67], v[92:95], v[44:47]
  ds_read_b128 v[92:95], v133 offset:2112
  v_mfma_f32_16x16x32_bf16 v[40:43], v[64:67], v[88:91], v[40:43]
  v_mfma_f32_16x16x32_bf16 v[36:39], v[64:67], v[84:87], v[36:39]
L_pad_57:
  s_cbranch_execz L_backB
  v_mfma_f32_16x16x32_bf16 v[32:35], v[64:67], v[80:83], v[32:35]
  ds_read_b64 v[64:65], v132 offset:2112
  ds_read_b64 v[66:67], v132 offset:2120
  v_mfma_f32_16x16x32_bf16 v[44:47], v[68:71], v[88:91], v[44:47]
  ds_read_b128 v[88:91], v133 offset:2624
  v_mfma_f32_16x16x32_bf16 v[40:43], v[68:71], v[84:87], v[40:43]
  v_mfma_f32_16x16x32_bf16 v[36:39], v[68:71], v[80:83], v[36:39]
  ds_read_b64 v[68:69], v132 offset:2624
  ds_read_b64 v[70:71], v132 offset:2632
  v_mfma_f32_16x16x32_bf16 v[44:47], v[72:75], v[84:87], v[44:47]
  ds_read_b128 v[84:87], v133 offset:3136
  v_mfma_f32_16x16x32_bf16 v[40:43], v[72:75], v[80:83], v[40:43]
  ds_read_b64 v[72:73], v132 offset:3136
  ds_read_b64 v[74:75], v132 offset:3144
  s_waitcnt lgkmcnt(15)
  v_mfma_f32_16x16x32_bf16 v[44:47], v[76:79], v[80:83], v[44:47]
  ds_read_b128 v[80:83], v133 offset:3648
  ds_read_b64 v[76:77], v132 offset:3648
  ds_read_b64 v[78:79], v132 offset:3656
  v_add_u32 v132, 64, v132
  v_add_u32 v133, 64, v133
  s_sub_u32 s18, s18, 1
  s_cbranch_scc0 L_conv
  s_setpc_b64 s[16:17]
L_poll:
  s_lshl4_add_u32 s3, s80, 0
  s_add_u32 m0, s91, 65536
  s_nop 0
  buffer_load_dwordx4 v0, s[64:67], s3 offen lds
  s_lshl4_add_u32 s3, s80, 458752
  s_add_u32 m0, s91, 73728
  s_nop 0
  buffer_load_dwordx4 v0, s[64:67], s3 offen lds
  s_lshl4_add_u32 s3, s81, 0
  s_add_u32 m0, s91, 81920
  s_nop 0
  buffer_load_dwordx4 v0, s[64:67], s3 offen lds
  s_lshl4_add_u32 s3, s81, 458752
  s_add_u32 m0, s91, 90112
  s_nop 0
  buffer_load_dwordx4 v0, s[64:67], s3 offen lds
  s_lshl4_add_u32 s3, s82, 0
  s_add_u32 m0, s91, 98304
  s_nop 0
  buffer_load_dwordx4 v0, s[64:67], s3 offen lds
  s_lshl4_add_u32 s3, s82, 458752
  s_add_u32 m0, s91, 106496
  s_nop 0
  buffer_load_dwordx4 v0, s[64:67], s3 offen lds
  s_waitcnt vmcnt(6)
  v_mov_b32 v140, 1
  s_mov_b64 exec, 1
  buffer_store_dword v140, off, s[48:51], s86 sc1
  s_mov_b64 exec, -1
  s_mul_i32 s8, s28, 8128
  s_add_u32 s8, s8, 64
  v_bfe_u32 v120, v1, 2, 2
  v_lshrrev_b32 v121, 5, v1
  v_lshl_add_u32 v120, v121, 2, v120
  v_and_b32 v121, 3, v1
  v_lshlrev_b32 v121, 3, v121
  v_lshl_add_u32 v120, v120, 7, v121
  v_and_b32 v121, 16, v1
  v_lshl_add_u32 v120, v121, 1, v120
  v_and_b32 v121, 8, v1
  v_lshl_add_u32 v120, v121, 3, v120
  v_xor_b32 v2, s8, v120
  v_xor_b32 v3, 64, v2
  v_add_u32 v10, 0x10000, v2
  v_add_u32 v11, 0x10000, v3
  s_lshl_b32 s8, s20, 12
  s_add_u32 s8, s8, 114688
  v_add_u32 v4, s8, v14
  v_xor_b32 v5, 8192, v4
  v_mov_b32 v9, 0xffffff00
  s_xor_b32 s6, s2, s29
  s_xor_b32 s6, s6, 1
  s_lshl2_add_u32 s6, s6, s90
  s_lshl_b32 s6, s6, 12
  s_add_u32 s6, s6, 16777216
  s_waitcnt vmcnt(1)
  s_barrier
  buffer_load_dword v128, v131, s[48:51], 0 offen sc1
  s_waitcnt vmcnt(0)
  v_cmp_eq_u32 vcc, 1, v128
  s_nop 0
  s_cmp_eq_u64 vcc, -1
  s_cbranch_scc1 L_done_26
  s_movk_i32 s18, 4095
L_poll_27:
  s_sleep 2
  buffer_load_dword v128, v131, s[48:51], 0 offen sc1
  s_waitcnt vmcnt(0)
  v_cmp_eq_u32 vcc, 1, v128
  s_nop 0
  s_cmp_eq_u64 vcc, -1
  s_cbranch_scc1 L_done_26
  s_sub_u32 s18, s18, 1
  s_cbranch_scc0 L_poll_27
L_done_26:
  buffer_load_dwordx4 v[176:179], v135, s[48:51], s76 offen offset:0 sc1
  buffer_load_dwordx4 v[180:183], v135, s[48:51], s76 offen offset:1024 sc1
  buffer_load_dwordx4 v[184:187], v135, s[48:51], s76 offen offset:2048 sc1
  buffer_load_dwordx4 v[188:191], v135, s[48:51], s76 offen offset:3072 sc1
  buffer_load_dwordx4 v[192:195], v135, s[48:51], s77 offen offset:0 sc1
  buffer_load_dwordx4 v[196:199], v135, s[48:51], s77 offen offset:1024 sc1
  buffer_load_dwordx4 v[200:203], v135, s[48:51], s77 offen offset:2048 sc1
  buffer_load_dwordx4 v[204:207], v135, s[48:51], s77 offen offset:3072 sc1
  buffer_load_dwordx4 v[208:211], v135, s[48:51], s78 offen offset:0 sc1
  buffer_load_dwordx4 v[212:215], v135, s[48:51], s78 offen offset:1024 sc1
  buffer_load_dwordx4 v[216:219], v135, s[48:51], s78 offen offset:2048 sc1
  buffer_load_dwordx4 v[220:223], v135, s[48:51], s78 offen offset:3072 sc1
  ds_read_b64_tr_b16 v[16:17], v2 offset:0
  ds_read_b64_tr_b16 v[18:19], v2 offset:1024
  ds_read_b64_tr_b16 v[20:21], v2 offset:2048
  ds_read_b64_tr_b16 v[22:23], v2 offset:3072
  ds_read_b64_tr_b16 v[24:25], v2 offset:4096
  ds_read_b64_tr_b16 v[26:27], v2 offset:5120
  ds_read_b64_tr_b16 v[28:29], v2 offset:6144
  ds_read_b64_tr_b16 v[30:31], v2 offset:7168
  s_waitcnt vmcnt(11) lgkmcnt(6)
  v_mfma_f32_32x32x16_bf16 v[48:63], v[16:19], v[176:179], 0
  ds_read_b64_tr_b16 v[32:33], v3 offset:0
  ds_read_b64_tr_b16 v[34:35], v3 offset:1024
  buffer_load_dwordx4 v[224:227], v135, s[48:51], s79 offen offset:0 sc1
  s_waitcnt vmcnt(11) lgkmcnt(6)
  v_mfma_f32_32x32x16_bf16 v[48:63], v[20:23], v[180:183], v[48:63]
  ds_read_b64_tr_b16 v[36:37], v2 offset:16384
  ds_read_b64_tr_b16 v[38:39], v2 offset:17408
  buffer_load_dwordx4 v[228:231], v135, s[48:51], s79 offen offset:1024 sc1
  s_waitcnt vmcnt(11) lgkmcnt(6)
  v_mfma_f32_32x32x16_bf16 v[48:63], v[24:27], v[184:187], v[48:63]
  ds_read_b64_tr_b16 v[16:17], v3 offset:2048
  ds_read_b64_tr_b16 v[18:19], v3 offset:3072
  buffer_load_dwordx4 v[232:235], v135, s[48:51], s79 offen offset:2048 sc1
  s_waitcnt vmcnt(11) lgkmcnt(6)
  v_mfma_f32_32x32x16_bf16 v[48:63], v[28:31], v[188:191], v[48:63]
  ds_read_b64_tr_b16 v[20:21], v2 offset:18432
  ds_read_b64_tr_b16 v[22:23], v2 offset:19456
  buffer_load_dwordx4 v[236:239], v135, s[48:51], s79 offen offset:3072 sc1
  s_waitcnt lgkmcnt(6)
  v_mfma_f32_32x32x16_bf16 v[64:79], v[32:35], v[176:179], 0
  ds_read_b64_tr_b16 v[24:25], v3 offset:4096
  ds_read_b64_tr_b16 v[26:27], v3 offset:5120
  s_waitcnt vmcnt(11) lgkmcnt(6)
  v_mfma_f32_32x32x16_bf16 v[48:63], v[36:39], v[192:195], v[48:63]
  ds_read_b64_tr_b16 v[28:29], v2 offset:20480
  ds_read_b64_tr_b16 v[30:31], v2 offset:21504
  buffer_load_dwordx4 v[240:243], v135, s[48:51], s80 offen offset:0 sc1
  s_waitcnt lgkmcnt(6)
  v_mfma_f32_32x32x16_bf16 v[64:79], v[16:19], v[180:183], v[64:79]
  ds_read_b64_tr_b16 v[32:33], v3 offset:6144
  ds_read_b64_tr_b16 v[34:35], v3 offset:7168
  s_waitcnt vmcnt(11) lgkmcnt(6)
  v_mfma_f32_32x32x16_bf16 v[48:63], v[20:23], v[196:199], v[48:63]
  ds_read_b64_tr_b16 v[36:37], v2 offset:22528
  ds_read_b64_tr_b16 v[38:39], v2 offset:23552
  buffer_load_dwordx4 v[244:247], v135, s[48:51], s80 offen offset:1024 sc1
  s_waitcnt lgkmcnt(6)
  v_mfma_f32_32x32x16_bf16 v[64:79], v[24:27], v[184:187], v[64:79]
  ds_read_b64_tr_b16 v[16:17], v3 offset:16384
  ds_read_b64_tr_b16 v[18:19], v3 offset:17408
  s_waitcnt vmcnt(11) lgkmcnt(6)
  v_mfma_f32_32x32x16_bf16 v[48:63], v[28:31], v[200:203], v[48:63]
  ds_read_b64_tr_b16 v[20:21], v2 offset:32768
  ds_read_b64_tr_b16 v[22:23], v2 offset:33792
  buffer_load_dwordx4 v[248:251], v135, s[48:51], s80 offen offset:2048 sc1
  s_waitcnt lgkmcnt(6)
L_pad_58:
  s_cbranch_execz L_backB
  v_mfma_f32_32x32x16_bf16 v[64:79], v[32:35], v[188:191], v[64:79]
  ds_read_b64_tr_b16 v[24:25], v3 offset:18432
  ds_read_b64_tr_b16 v[26:27], v3 offset:19456
  s_waitcnt vmcnt(11) lgkmcnt(6)
  v_mfma_f32_32x32x16_bf16 v[48:63], v[36:39], v[204:207], v[48:63]
  ds_read_b64_tr_b16 v[28:29], v2 offset:34816
  ds_read_b64_tr_b16 v[30:31], v2 offset:35840
  buffer_load_dwordx4 v[252:255], v135, s[48:51], s80 offen offset:3072 sc1
  s_waitcnt lgkmcnt(6)
  v_mfma_f32_32x32x16_bf16 v[64:79], v[16:19], v[192:195], v[64:79]
  ds_read_b64_tr_b16 v[32:33], v3 offset:20480
  ds_read_b64_tr_b16 v[34:35], v3 offset:21504
  s_waitcnt vmcnt(11) lgkmcnt(6)
  v_mfma_f32_32x32x16_bf16 v[48:63], v[20:23], v[208:211], v[48:63]
  ds_read_b64_tr_b16 v[36:37], v2 offset:36864
  ds_read_b64_tr_b16 v[38:39], v2 offset:37888
  buffer_load_dwordx4 v[176:179], v135, s[48:51], s81 offen offset:0 sc1
  s_waitcnt lgkmcnt(6)
  v_mfma_f32_32x32x16_bf16 v[64:79], v[24:27], v[196:199], v[64:79]
  ds_read_b64_tr_b16 v[16:17], v3 offset:22528
  ds_read_b64_tr_b16 v[18:19], v3 offset:23552
  s_waitcnt vmcnt(11) lgkmcnt(6)
  v_mfma_f32_32x32x16_bf16 v[48:63], v[28:31], v[212:215], v[48:63]
  ds_read_b64_tr_b16 v[20:21], v2 offset:38912
  ds_read_b64_tr_b16 v[22:23], v2 offset:39936
  buffer_load_dwordx4 v[180:183], v135, s[48:51], s81 offen offset:1024 sc1
  s_waitcnt lgkmcnt(6)
  v_mfma_f32_32x32x16_bf16 v[64:79], v[32:35], v[200:203], v[64:79]
  ds_read_b64_tr_b16 v[24:25], v3 offset:32768
  ds_read_b64_tr_b16 v[26:27], v3 offset:33792
  s_waitcnt vmcnt(11) lgkmcnt(6)
  v_mfma_f32_32x32x16_bf16 v[48:63], v[36:39], v[216:219], v[48:63]
  ds_read_b64_tr_b16 v[28:29], v2 offset:49152
  ds_read_b64_tr_b16 v[30:31], v2 offset:50176
  buffer_load_dwordx4 v[184:187], v135, s[48:51], s81 offen offset:2048 sc1
  s_waitcnt lgkmcnt(6)
  v_mfma_f32_32x32x16_bf16 v[64:79], v[16:19], v[204:207], v[64:79]
  ds_read_b64_tr_b16 v[32:33], v3 offset:34816
  ds_read_b64_tr_b16 v[34:35], v3 offset:35840
  s_waitcnt vmcnt(11) lgkmcnt(6)
  v_mfma_f32_32x32x16_bf16 v[48:63], v[20:23], v[220:223], v[48:63]
  ds_read_b64_tr_b16 v[36:37], v2 offset:51200
  ds_read_b64_tr_b16 v[38:39], v2 offset:52224
  buffer_load_dwordx4 v[188:191], v135, s[48:51], s81 offen offset:3072 sc1
  s_waitcnt lgkmcnt(6)
  v_mfma_f32_32x32x16_bf16 v[64:79], v[24:27], v[208:211], v[64:79]
  ds_read_b64_tr_b16 v[16:17], v3 offset:36864
  ds_read_b64_tr_b16 v[18:19], v3 offset:37888
  s_waitcnt vmcnt(11) lgkmcnt(6)
  v_mfma_f32_32x32x16_bf16 v[48:63], v[28:31], v[224:227], v[48:63]
  ds_read_b64_tr_b16 v[20:21], v2 offset:53248
  ds_read_b64_tr_b16 v[22:23], v2 offset:54272
  buffer_load_dwordx4 v[192:195], v135, s[48:51], s82 offen offset:0 sc1
  s_waitcnt lgkmcnt(6)
  v_mfma_f32_32x32x16_bf16 v[64:79], v[32:35], v[212:215], v[64:79]
  ds_read_b64_tr_b16 v[24:25], v3 offset:38912
  ds_read_b64_tr_b16 v[26:27], v3 offset:39936
  s_waitcnt vmcnt(11) lgkmcnt(6)
  v_mfma_f32_32x32x16_bf16 v[48:63], v[36:39], v[228:231], v[48:63]
  ds_read_b64_tr_b16 v[28:29], v2 offset:55296
  ds_read_b64_tr_b16 v[30:31], v2 offset:56320
  buffer_load_dwordx4 v[196:199], v135, s[48:51], s82 offen offset:1024 sc1
  s_waitcnt lgkmcnt(6)
  v_mfma_f32_32x32x16_bf16 v[64:79], v[16:19], v[216:219], v[64:79]
  ds_read_b64_tr_b16 v[32:33], v3 offset:49152
  ds_read_b64_tr_b16 v[34:35], v3 offset:50176
  s_waitcnt vmcnt(11) lgkmcnt(6)
  v_mfma_f32_32x32x16_bf16 v[48:63], v[20:23], v[232:235], v[48:63]
  ds_read_b64_tr_b16 v[36:37], v10 offset:0
  ds_read_b64_tr_b16 v[38:39], v10 offset:1024
  buffer_load_dwordx4 v[200:203], v135, s[48:51], s82 offen offset:2048 sc1
  s_waitcnt lgkmcnt(6)
  v_mfma_f32_32x32x16_bf16 v[64:79], v[24:27], v[220:223], v[64:79]
  ds_read_b64_tr_b16 v[16:17], v3 offset:51200
  ds_read_b64_tr_b16 v[18:19], v3 offset:52224
  s_waitcnt vmcnt(11) lgkmcnt(6)
  v_mfma_f32_32x32x16_bf16 v[48:63], v[28:31], v[236:239], v[48:63]
  ds_read_b64_tr_b16 v[20:21], v10 offset:2048
  ds_read_b64_tr_b16 v[22:23], v10 offset:3072
  buffer_load_dwordx4 v[204:207], v135, s[48:51], s82 offen offset:3072 sc1
  s_barrier
  s_waitcnt lgkmcnt(6)
  v_mfma_f32_32x32x16_bf16 v[64:79], v[32:35], v[224:227], v[64:79]
  ds_read_b64_tr_b16 v[24:25], v3 offset:53248
  ds_read_b64_tr_b16 v[26:27], v3 offset:54272
  s_waitcnt vmcnt(11) lgkmcnt(6)
  v_mfma_f32_32x32x16_bf16 v[48:63], v[36:39], v[240:243], v[48:63]
  ds_read_b64_tr_b16 v[28:29], v10 offset:4096
  ds_read_b64_tr_b16 v[30:31], v10 offset:5120
  s_waitcnt lgkmcnt(6)
  v_mfma_f32_32x32x16_bf16 v[64:79], v[16:19], v[228:231], v[64:79]
  ds_read_b64_tr_b16 v[32:33], v3 offset:55296
  ds_read_b64_tr_b16 v[34:35], v3 offset:56320
  s_waitcnt vmcnt(10) lgkmcnt(6)
  v_mfma_f32_32x32x16_bf16 v[48:63], v[20:23], v[244:247], v[48:63]
  ds_read_b64_tr_b16 v[36:37], v10 offset:6144
  ds_read_b64_tr_b16 v[38:39], v10 offset:7168
  s_waitcnt lgkmcnt(6)
  v_mfma_f32_32x32x16_bf16 v[64:79], v[24:27], v[232:235], v[64:79]
  ds_read_b64_tr_b16 v[16:17], v11 offset:0
  ds_read_b64_tr_b16 v[18:19], v11 offset:1024
  s_waitcnt vmcnt(9) lgkmcnt(6)
  v_mfma_f32_32x32x16_bf16 v[48:63], v[28:31], v[248:251], v[48:63]
  ds_read_b64_tr_b16 v[20:21], v10 offset:16384
  ds_read_b64_tr_b16 v[22:23], v10 offset:17408
  s_waitcnt lgkmcnt(6)
  v_mfma_f32_32x32x16_bf16 v[64:79], v[32:35], v[236:239], v[64:79]
  ds_read_b64_tr_b16 v[24:25], v11 offset:2048
  ds_read_b64_tr_b16 v[26:27], v11 offset:3072
  s_waitcnt vmcnt(8) lgkmcnt(6)
  v_mfma_f32_32x32x16_bf16 v[48:63], v[36:39], v[252:255], v[48:63]
  ds_read_b64_tr_b16 v[28:29], v10 offset:18432
  ds_read_b64_tr_b16 v[30:31], v10 offset:19456
  s_waitcnt lgkmcnt(6)
  v_mfma_f32_32x32x16_bf16 v[64:79], v[16:19], v[240:243], v[64:79]
  ds_read_b64_tr_b16 v[32:33], v11 offset:4096
  ds_read_b64_tr_b16 v[34:35], v11 offset:5120
  s_waitcnt vmcnt(7) lgkmcnt(6)
  v_mfma_f32_32x32x16_bf16 v[48:63], v[20:23], v[176:179], v[48:63]
  ds_read_b64_tr_b16 v[36:37], v10 offset:20480
  ds_read_b64_tr_b16 v[38:39], v10 offset:21504
  s_waitcnt lgkmcnt(6)
  v_mfma_f32_32x32x16_bf16 v[64:79], v[24:27], v[244:247], v[64:79]
  ds_read_b64_tr_b16 v[16:17], v11 offset:6144
  ds_read_b64_tr_b16 v[18:19], v11 offset:7168
  s_waitcnt vmcnt(6) lgkmcnt(6)
  v_mfma_f32_32x32x16_bf16 v[48:63], v[28:31], v[180:183], v[48:63]
  ds_read_b64_tr_b16 v[20:21], v10 offset:22528
  ds_read_b64_tr_b16 v[22:23], v10 offset:23552
  s_waitcnt lgkmcnt(6)
  v_mfma_f32_32x32x16_bf16 v[64:79], v[32:35], v[248:251], v[64:79]
  ds_read_b64_tr_b16 v[24:25], v11 offset:16384
  ds_read_b64_tr_b16 v[26:27], v11 offset:17408
  s_waitcnt vmcnt(5) lgkmcnt(6)
  v_mfma_f32_32x32x16_bf16 v[48:63], v[36:39], v[184:187], v[48:63]
  ds_read_b64_tr_b16 v[28:29], v10 offset:32768
  ds_read_b64_tr_b16 v[30:31], v10 offset:33792
  s_waitcnt lgkmcnt(6)
  v_mfma_f32_32x32x16_bf16 v[64:79], v[16:19], v[252:255], v[64:79]
  ds_read_b64_tr_b16 v[32:33], v11 offset:18432
  ds_read_b64_tr_b16 v[34:35], v11 offset:19456
  s_waitcnt vmcnt(4) lgkmcnt(6)
  v_mfma_f32_32x32x16_bf16 v[48:63], v[20:23], v[188:191], v[48:63]
  ds_read_b64_tr_b16 v[36:37], v10 offset:34816
  ds_read_b64_tr_b16 v[38:39], v10 offset:35840
  s_waitcnt lgkmcnt(6)
  v_mfma_f32_32x32x16_bf16 v[64:79], v[24:27], v[176:179], v[64:79]
  ds_read_b64_tr_b16 v[16:17], v11 offset:20480
  ds_read_b64_tr_b16 v[18:19], v11 offset:21504
  s_waitcnt vmcnt(3) lgkmcnt(6)
  v_mfma_f32_32x32x16_bf16 v[48:63], v[28:31], v[192:195], v[48:63]
  ds_read_b64_tr_b16 v[20:21], v10 offset:36864
  ds_read_b64_tr_b16 v[22:23], v10 offset:37888
  s_waitcnt lgkmcnt(6)
L_pad_59:
  s_cbranch_execz L_backB
  v_mfma_f32_32x32x16_bf16 v[64:79], v[32:35], v[180:183], v[64:79]
  ds_read_b64_tr_b16 v[24:25], v11 offset:22528
  ds_read_b64_tr_b16 v[26:27], v11 offset:23552
  s_waitcnt vmcnt(2) lgkmcnt(6)
  v_mfma_f32_32x32x16_bf16 v[48:63], v[36:39], v[196:199], v[48:63]
  ds_read_b64_tr_b16 v[28:29], v10 offset:38912
  ds_read_b64_tr_b16 v[30:31], v10 offset:39936
  s_waitcnt lgkmcnt(6)
  v_mfma_f32_32x32x16_bf16 v[64:79], v[16:19], v[184:187], v[64:79]
  ds_read_b64_tr_b16 v[32:33], v11 offset:32768
  ds_read_b64_tr_b16 v[34:35], v11 offset:33792
  s_waitcnt vmcnt(1) lgkmcnt(6)
  v_mfma_f32_32x32x16_bf16 v[48:63], v[20:23], v[200:203], v[48:63]
  ds_read_b64_tr_b16 v[36:37], v11 offset:34816
  ds_read_b64_tr_b16 v[38:39], v11 offset:35840
  s_waitcnt lgkmcnt(6)
  v_mfma_f32_32x32x16_bf16 v[64:79], v[24:27], v[188:191], v[64:79]
  ds_read_b64_tr_b16 v[16:17], v11 offset:36864
  ds_read_b64_tr_b16 v[18:19], v11 offset:37888
  s_waitcnt vmcnt(0) lgkmcnt(6)
  v_mfma_f32_32x32x16_bf16 v[48:63], v[28:31], v[204:207], v[48:63]
  ds_read_b64_tr_b16 v[20:21], v11 offset:38912
  ds_read_b64_tr_b16 v[22:23], v11 offset:39936
  s_waitcnt lgkmcnt(6)
  v_mfma_f32_32x32x16_bf16 v[64:79], v[32:35], v[192:195], v[64:79]
  s_nop 7
  ds_write_b128 v4, v[48:51] offset:0
  ds_write_b128 v4, v[52:55] offset:1024
  ds_write_b128 v4, v[56:59] offset:2048
  ds_write_b128 v4, v[60:63] offset:3072
  s_waitcnt lgkmcnt(8)
  v_mfma_f32_32x32x16_bf16 v[64:79], v[36:39], v[196:199], v[64:79]
  s_waitcnt lgkmcnt(6)
  v_mfma_f32_32x32x16_bf16 v[64:79], v[16:19], v[200:203], v[64:79]
  s_waitcnt lgkmcnt(0)
  s_barrier
  ds_read_b128 v[80:83], v5 offset:0
  ds_read_b128 v[84:87], v5 offset:1024
  ds_read_b128 v[88:91], v5 offset:2048
  ds_read_b128 v[92:95], v5 offset:3072
  v_mfma_f32_32x32x16_bf16 v[64:79], v[20:23], v[204:207], v[64:79]
  s_waitcnt lgkmcnt(3)
  s_nop 10
  v_pk_add_f32 v[80:81], v[80:81], v[64:65]
  v_pk_add_f32 v[82:83], v[82:83], v[66:67]
  s_waitcnt lgkmcnt(2)
  v_pk_add_f32 v[84:85], v[84:85], v[68:69]
  v_pk_add_f32 v[86:87], v[86:87], v[70:71]
  v_cvt_pk_bf16_f32 v16, v80, v81
  v_cvt_pk_bf16_f32 v17, v82, v83
  v_cvt_pk_bf16_f32 v18, v84, v85
  v_cvt_pk_bf16_f32 v19, v86, v87
  buffer_store_dwordx4 v[16:19], v14, s[48:51], s6 offen offset:0 sc1
  v_add3_u32 v24, v16, v17, s37
  v_add3_u32 v24, v18, v19, v24
  s_waitcnt lgkmcnt(1)
  v_pk_add_f32 v[88:89], v[88:89], v[72:73]
  v_pk_add_f32 v[90:91], v[90:91], v[74:75]
  s_waitcnt lgkmcnt(0)
  v_pk_add_f32 v[92:93], v[92:93], v[76:77]
  v_pk_add_f32 v[94:95], v[94:95], v[78:79]
  v_cvt_pk_bf16_f32 v20, v88, v89
  v_cvt_pk_bf16_f32 v21, v90, v91
  v_cvt_pk_bf16_f32 v22, v92, v93
  v_cvt_pk_bf16_f32 v23, v94, v95
  buffer_store_dwordx4 v[20:23], v14, s[48:51], s6 offen offset:1024 sc1
  v_add3_u32 v24, v20, v21, v24
  v_add3_u32 v24, v22, v23, v24
  v_lshlrev_b32 v25, 2, v1
  buffer_store_dword v24, v25, s[48:51], s6 offen offset:2048 sc1
  s_barrier
  s_branch L_dump
L_cv:
  s_waitcnt vmcnt(4)
  ds_read_b128 v[108:111], v133 offset:0
  ds_read_b64 v[48:49], v132 offset:0
  ds_read_b64 v[50:51], v132 offset:8
  ds_read_b128 v[104:107], v133 offset:512
  ds_read_b64 v[52:53], v132 offset:512
  ds_read_b64 v[54:55], v132 offset:520
  ds_read_b128 v[100:103], v133 offset:1024
  ds_read_b64 v[56:57], v132 offset:1024
  ds_read_b64 v[58:59], v132 offset:1032
  ds_read_b128 v[96:99], v133 offset:1536
  ds_read_b64 v[60:61], v132 offset:1536
  ds_read_b64 v[62:63], v132 offset:1544
  ds_read_b128 v[92:95], v133 offset:2048
  ds_read_b64 v[64:65], v132 offset:2048
  ds_read_b64 v[66:67], v132 offset:2056
  ds_read_b128 v[88:91], v133 offset:2560
  ds_read_b64 v[68:69], v132 offset:2560
  ds_read_b64 v[70:71], v132 offset:2568
  ds_read_b128 v[84:87], v133 offset:3072
  ds_read_b64 v[72:73], v132 offset:3072
  ds_read_b64 v[74:75], v132 offset:3080
  ds_read_b128 v[80:83], v133 offset:3584
  ds_read_b64 v[76:77], v132 offset:3584
  ds_read_b64 v[78:79], v132 offset:3592
  s_mul_i32 s8, s28, 96
  s_add_u32 s8, s8, s27
  s_lshl_b32 s8, s8, 8
  s_add_u32 s8, s8, 114688
  v_lshrrev_b32 v112, 3, v1
  v_mul_u32_u24 v112, 384, v112
  v_add3_u32 v112, v112, v14, s8
  v_xor_b32 v113, 256, v112
  v_lshl_add_u32 v114, v1, 2, s8
  v_xor_b32 v115, 256, v114
  v_mov_b32 v118, v122
  v_and_b32 v119, 0xffff0000, v244
  s_nop 0
  v_permlane32_swap_b32 v122, v118
  s_and_b32 s8, s24, 1
  s_lshr_b32 s9, s24, 1
  s_lshl_b32 s9, s9, 14
  s_lshl_b32 s10, s8, 10
  s_add_u32 s9, s9, s10
  s_add_u32 s9, s9, 12648452
  s_mul_i32 s10, s8, 7
  s_sub_u32 s10, s10, 1
  s_add_u32 s8, s8, 14
  s_lshl_b32 s11, s28, 2
  v_bfe_u32 v123, v1, 2, 2
  v_add_u32 v123, s11, v123
  v_cmp_eq_u32 vcc, 0, v123
  v_add_u32 v123, s10, v123
  v_mov_b32 v122, s8
  v_cndmask_b32 v123, v123, v122, vcc
  v_and_b32 v122, 3, v1
  v_lshl_add_u32 v122, v122, 12, s9
  v_lshl_add_u32 v122, v123, 6, v122
  s_waitcnt lgkmcnt(15)
  v_mfma_f32_16x16x32_bf16 v[44:47], v[136:139], v[108:111], 0
  v_mfma_f32_16x16x32_bf16 v[40:43], v[136:139], v[104:107], 0
  v_mfma_f32_16x16x32_bf16 v[36:39], v[136:139], v[100:103], 0
  s_waitcnt lgkmcnt(14)
  v_mfma_f32_16x16x32_bf16 v[32:35], v[136:139], v[96:99], 0
  s_waitcnt lgkmcnt(11)
  v_mfma_f32_16x16x32_bf16 v[28:31], v[136:139], v[92:95], 0
  s_waitcnt lgkmcnt(8)
  v_mfma_f32_16x16x32_bf16 v[24:27], v[136:139], v[88:91], 0
  s_waitcnt lgkmcnt(5)
  v_mfma_f32_16x16x32_bf16 v[20:23], v[136:139], v[84:87], 0
  s_waitcnt lgkmcnt(2)
  v_mfma_f32_16x16x32_bf16 v[16:19], v[136:139], v[80:83], 0
  s_lshl4_add_u32 s3, s80, 0
  s_add_u32 m0, s91, 65536
  s_nop 0
  buffer_load_dwordx4 v0, s[64:67], s3 offen lds
  s_lshl4_add_u32 s3, s80, 458752
  s_add_u32 m0, s91, 73728
  s_nop 0
  buffer_load_dwordx4 v0, s[64:67], s3 offen lds
  s_lshl4_add_u32 s3, s81, 0
  s_add_u32 m0, s91, 81920
  s_nop 0
  buffer_load_dwordx4 v0, s[64:67], s3 offen lds
  s_lshl4_add_u32 s3, s81, 458752
  s_add_u32 m0, s91, 90112
  s_nop 0
  buffer_load_dwordx4 v0, s[64:67], s3 offen lds
  s_lshl4_add_u32 s3, s82, 0
  s_add_u32 m0, s91, 98304
  s_nop 0
L_pad_60:
  s_cbranch_execz L_backB
  buffer_load_dwordx4 v0, s[64:67], s3 offen lds
  s_lshl4_add_u32 s3, s82, 458752
  s_add_u32 m0, s91, 106496
  s_nop 0
  buffer_load_dwordx4 v0, s[64:67], s3 offen lds
  s_mov_b32 s18, 0
  s_call_b64 s[16:17], L_conv
  s_waitcnt vmcnt(6)
  v_mov_b32 v140, 1
  s_mov_b64 exec, 1
  buffer_store_dword v140, off, s[48:51], s86 sc1
  s_mov_b64 exec, -1
  s_mov_b32 s18, 1
  s_call_b64 s[16:17], L_conv
  s_waitcnt vmcnt(1)
  s_barrier
  s_mov_b32 s18, 0
  s_call_b64 s[16:17], L_conv
  s_lshl1_add_u32 s9, s87, s28
  s_lshl_b32 s9, s9, 6
  s_lshl_b32 s10, s27, 18
  s_add_u32 s9, s9, s10
  s_add_u32 s9, s9, 20971520
  v_mov_b32 v140, 0xffffff00
  s_movk_i32 s18, 4095
  s_cmp_eq_u32 s27, 0
  s_cbranch_scc1 L_xa_20
  ds_write_b128 v112, v[16:19] offset:64
  ds_write_b128 v112, v[24:27] offset:4224
  ds_write_b128 v112, v[32:35] offset:15552
  ds_write_b128 v112, v[40:43] offset:19712
  s_branch L_xb_21
L_xa_20:
  ds_write_b128 v112, v[20:23] offset:64
  ds_write_b128 v112, v[28:31] offset:4224
  ds_write_b128 v112, v[36:39] offset:15552
  ds_write_b128 v112, v[44:47] offset:19712
L_xb_21:
  ds_write_b32 v114, v140 offset:14848
L_xp_24:
  ds_read_b32 v116, v115 offset:14848
  ds_read_b128 v[48:51], v113 offset:64
  ds_read_b128 v[52:55], v113 offset:4224
  ds_read_b128 v[56:59], v113 offset:15552
  ds_read_b128 v[60:63], v113 offset:19712
  s_waitcnt lgkmcnt(0)
  v_cmp_ne_u32 vcc, 0, v116
  s_nop 0
  s_cmp_eq_u64 vcc, -1
  s_cbranch_scc1 L_xq_25
  s_sub_u32 s18, s18, 1
  s_cbranch_scc0 L_xp_24
L_xq_25:
  s_cmp_eq_u32 s27, 0
  s_cbranch_scc1 L_xc_22
  v_add_f32 v48, v48, v20
  v_add_f32 v49, v49, v21
  v_add_f32 v50, v50, v22
  v_add_f32 v51, v51, v23
  v_add_f32 v52, v52, v28
  v_add_f32 v53, v53, v29
  v_add_f32 v54, v54, v30
  v_add_f32 v55, v55, v31
  v_add_f32 v56, v56, v36
  v_add_f32 v57, v57, v37
  v_add_f32 v58, v58, v38
  v_add_f32 v59, v59, v39
  v_add_f32 v60, v60, v44
  v_add_f32 v61, v61, v45
  v_add_f32 v62, v62, v46
  v_add_f32 v63, v63, v47
  s_branch L_xd_23
L_xc_22:
  v_add_f32 v48, v48, v16
  v_add_f32 v49, v49, v17
  v_add_f32 v50, v50, v18
  v_add_f32 v51, v51, v19
  v_add_f32 v52, v52, v24
  v_add_f32 v53, v53, v25
  v_add_f32 v54, v54, v26
  v_add_f32 v55, v55, v27
  v_add_f32 v56, v56, v32
  v_add_f32 v57, v57, v33
  v_add_f32 v58, v58, v34
  v_add_f32 v59, v59, v35
  v_add_f32 v60, v60, v40
  v_add_f32 v61, v61, v41
  v_add_f32 v62, v62, v42
  v_add_f32 v63, v63, v43
L_xd_23:
  buffer_load_dword v128, v131, s[48:51], 0 offen sc1
  buffer_load_dword v123, v122, s[48:51], 0 offen sc1
  v_cvt_pk_bf16_f32 v48, v48, v49
  v_cvt_pk_bf16_f32 v49, v50, v51
  buffer_store_dwordx2 v[48:49], v134, s[48:51], s9 offen sc1
  s_add_u32 s9, s9, 524288
  v_cvt_pk_bf16_f32 v52, v52, v53
  v_cvt_pk_bf16_f32 v53, v54, v55
  buffer_store_dwordx2 v[52:53], v134, s[48:51], s9 offen sc1
  s_add_u32 s9, s9, 524288
  v_cvt_pk_bf16_f32 v56, v56, v57
  v_cvt_pk_bf16_f32 v57, v58, v59
  buffer_store_dwordx2 v[56:57], v134, s[48:51], s9 offen sc1
  s_add_u32 s9, s9, 524288
  v_cvt_pk_bf16_f32 v60, v60, v61
  v_cvt_pk_bf16_f32 v61, v62, v63
  buffer_store_dwordx2 v[60:61], v134, s[48:51], s9 offen sc1
  s_add_u32 s9, s9, 524288
  s_setprio 0
  s_mul_i32 s8, s28, 8128
  s_add_u32 s8, s8, 64
  v_bfe_u32 v120, v1, 2, 2
  v_lshrrev_b32 v121, 5, v1
  v_lshl_add_u32 v120, v121, 2, v120
  v_and_b32 v121, 3, v1
  v_lshlrev_b32 v121, 3, v121
  v_lshl_add_u32 v120, v120, 7, v121
  v_and_b32 v121, 16, v1
  v_lshl_add_u32 v120, v121, 1, v120
  v_and_b32 v121, 8, v1
  v_lshl_add_u32 v120, v121, 3, v120
  v_xor_b32 v2, s8, v120
  v_xor_b32 v3, 64, v2
  v_add_u32 v10, 0x10000, v2
  v_add_u32 v11, 0x10000, v3
  s_lshl_b32 s8, s20, 12
  s_add_u32 s8, s8, 114688
  v_add_u32 v4, s8, v14
  v_xor_b32 v5, 8192, v4
  v_mov_b32 v9, 0xffffff00
  s_xor_b32 s6, s2, s29
  s_xor_b32 s6, s6, 1
  s_lshl2_add_u32 s6, s6, s90
  s_lshl_b32 s6, s6, 12
  s_add_u32 s6, s6, 16777216
  s_lshl_b32 s9, s90, 11
  s_add_u32 s9, s9, 147456
  v_lshrrev_b32 v112, 5, v1
  v_bfe_u32 v113, v1, 2, 2
  v_lshl_add_u32 v112, v112, 2, v113
  v_lshl_add_u32 v8, v112, 6, s9
  v_and_b32 v112, 16, v1
  v_lshl_add_u32 v8, v112, 1, v8
  v_and_b32 v112, 3, v1
  v_lshl_add_u32 v8, v112, 3, v8
  s_mov_b32 m0, s9
  v_mov_b32 v114, 0xbfb8aa3b
  v_mov_b32 v115, 0xbfb8aa3b
  v_mov_b32 v116, 1.0
  v_mov_b32 v117, 1.0
  s_lshl1_add_u32 s8, s24, s28
  s_lshl4_add_u32 s10, s89, s8
  s_lshl_b32 s10, s10, 11
  s_add_u32 s10, s10, 20971520
  s_waitcnt vmcnt(5)
  v_cmp_eq_u32 vcc, 1, v128
  s_nop 0
  s_cmp_eq_u64 vcc, -1
  s_cbranch_scc1 L_done_28
  s_movk_i32 s18, 4095
L_poll_29:
  s_sleep 2
  buffer_load_dword v128, v131, s[48:51], 0 offen sc1
  s_waitcnt vmcnt(0)
  v_cmp_eq_u32 vcc, 1, v128
  s_nop 0
  s_cmp_eq_u64 vcc, -1
  s_cbranch_scc1 L_done_28
  s_sub_u32 s18, s18, 1
  s_cbranch_scc0 L_poll_29
L_done_28:
  s_waitcnt vmcnt(4)
  v_cmp_eq_u32 vcc, 1, v123
  s_nop 0
  s_cmp_eq_u64 vcc, -1
  s_cbranch_scc1 L_done_30
  s_movk_i32 s18, 4095
L_poll_31:
  s_sleep 2
  buffer_load_dword v123, v122, s[48:51], 0 offen sc1
  s_waitcnt vmcnt(0)
  v_cmp_eq_u32 vcc, 1, v123
  s_nop 0
  s_cmp_eq_u64 vcc, -1
  s_cbranch_scc1 L_done_30
  s_sub_u32 s18, s18, 1
  s_cbranch_scc0 L_poll_31
L_done_30:
  s_barrier
  buffer_load_dwordx4 v[176:179], v135, s[48:51], s76 offen offset:0 sc1
  buffer_load_dwordx4 v[180:183], v135, s[48:51], s76 offen offset:1024 sc1
  buffer_load_dwordx4 v[184:187], v135, s[48:51], s76 offen offset:2048 sc1
  buffer_load_dwordx4 v[188:191], v135, s[48:51], s76 offen offset:3072 sc1
  buffer_load_dwordx4 v[192:195], v135, s[48:51], s77 offen offset:0 sc1
  buffer_load_dwordx4 v[196:199], v135, s[48:51], s77 offen offset:1024 sc1
  buffer_load_dwordx4 v[200:203], v135, s[48:51], s77 offen offset:2048 sc1
  buffer_load_dwordx4 v[204:207], v135, s[48:51], s77 offen offset:3072 sc1
  buffer_load_dwordx4 v[208:211], v135, s[48:51], s78 offen offset:0 sc1
  buffer_load_dwordx4 v[212:215], v135, s[48:51], s78 offen offset:1024 sc1
  buffer_load_dwordx4 v[216:219], v135, s[48:51], s78 offen offset:2048 sc1
  buffer_load_dwordx4 v[220:223], v135, s[48:51], s78 offen offset:3072 sc1
  v_permlane32_swap_b32 v168, v170
  v_permlane32_swap_b32 v169, v171
  v_permlane32_swap_b32 v172, v174
  v_permlane32_swap_b32 v173, v175
  v_lshlrev_b32 v96, 16, v168
  v_and_b32 v97, 0xffff0000, v168
L_pad_61:
  s_cbranch_execz L_backB
  v_lshlrev_b32 v98, 16, v169
  v_and_b32 v99, 0xffff0000, v169
  v_lshlrev_b32 v100, 16, v170
  v_and_b32 v101, 0xffff0000, v170
  v_lshlrev_b32 v102, 16, v171
  v_and_b32 v103, 0xffff0000, v171
  v_lshlrev_b32 v104, 16, v172
  v_and_b32 v105, 0xffff0000, v172
  v_lshlrev_b32 v106, 16, v173
  v_and_b32 v107, 0xffff0000, v173
  v_lshlrev_b32 v108, 16, v174
  v_and_b32 v109, 0xffff0000, v174
  v_lshlrev_b32 v110, 16, v175
  v_and_b32 v111, 0xffff0000, v175
  v_add_f32 v80, v96, v119
  v_add_f32 v81, v97, v119
  v_add_f32 v82, v98, v119
  v_add_f32 v83, v99, v119
  v_add_f32 v84, v100, v119
  v_add_f32 v85, v101, v119
  v_add_f32 v86, v102, v119
  v_add_f32 v87, v103, v119
  v_add_f32 v88, v104, v119
  v_add_f32 v89, v105, v119
  v_add_f32 v90, v106, v119
  v_add_f32 v91, v107, v119
  v_add_f32 v92, v108, v119
  v_add_f32 v93, v109, v119
  v_add_f32 v94, v110, v119
  v_add_f32 v95, v111, v119
  v_mul_f32 v80, v80, v118
  v_mul_f32 v81, v81, v118
  v_mul_f32 v82, v82, v118
  v_mul_f32 v83, v83, v118
  v_mul_f32 v84, v84, v118
  v_mul_f32 v85, v85, v118
  v_mul_f32 v86, v86, v118
  v_mul_f32 v87, v87, v118
  v_mul_f32 v88, v88, v118
  v_mul_f32 v89, v89, v118
  v_mul_f32 v90, v90, v118
  v_mul_f32 v91, v91, v118
  v_mul_f32 v92, v92, v118
  v_mul_f32 v93, v93, v118
  v_mul_f32 v94, v94, v118
  v_mul_f32 v95, v95, v118
  s_barrier
  ds_read_b64_tr_b16 v[16:17], v2 offset:0
  ds_read_b64_tr_b16 v[18:19], v2 offset:1024
  ds_read_b64_tr_b16 v[20:21], v2 offset:2048
  ds_read_b64_tr_b16 v[22:23], v2 offset:3072
  ds_read_b64_tr_b16 v[24:25], v2 offset:4096
  ds_read_b64_tr_b16 v[26:27], v2 offset:5120
  ds_read_b64_tr_b16 v[28:29], v2 offset:6144
  ds_read_b64_tr_b16 v[30:31], v2 offset:7168
  s_waitcnt vmcnt(11) lgkmcnt(6)
  v_mfma_f32_32x32x16_bf16 v[48:63], v[16:19], v[176:179], 0
  ds_read_b64_tr_b16 v[32:33], v2 offset:16384
  ds_read_b64_tr_b16 v[34:35], v2 offset:17408
  buffer_load_dwordx4 v[224:227], v135, s[48:51], s79 offen offset:0 sc1
  buffer_load_dwordx4 v14, s[48:51], s10 offen offset:0 sc1 lds
  buffer_load_dwordx4 v14, s[48:51], s10 offen offset:1024 sc1 lds
  v_lshlrev_b32 v121, 2, v1
  s_waitcnt vmcnt(13) lgkmcnt(6)
  v_mfma_f32_32x32x16_bf16 v[48:63], v[20:23], v[180:183], v[48:63]
  ds_read_b64_tr_b16 v[36:37], v2 offset:18432
  ds_read_b64_tr_b16 v[38:39], v2 offset:19456
  buffer_load_dwordx4 v[228:231], v135, s[48:51], s79 offen offset:1024 sc1
  s_waitcnt vmcnt(13) lgkmcnt(6)
  v_mfma_f32_32x32x16_bf16 v[48:63], v[24:27], v[184:187], v[48:63]
  ds_read_b64_tr_b16 v[16:17], v2 offset:20480
  ds_read_b64_tr_b16 v[18:19], v2 offset:21504
  buffer_load_dwordx4 v[232:235], v135, s[48:51], s79 offen offset:2048 sc1
  s_waitcnt vmcnt(13) lgkmcnt(6)
  v_mfma_f32_32x32x16_bf16 v[48:63], v[28:31], v[188:191], v[48:63]
  ds_read_b64_tr_b16 v[20:21], v3 offset:0
  ds_read_b64_tr_b16 v[22:23], v3 offset:1024
  buffer_load_dwordx4 v[236:239], v135, s[48:51], s79 offen offset:3072 sc1
  s_waitcnt vmcnt(13) lgkmcnt(6)
  v_mfma_f32_32x32x16_bf16 v[48:63], v[32:35], v[192:195], v[48:63]
  ds_read_b64_tr_b16 v[24:25], v2 offset:22528
  ds_read_b64_tr_b16 v[26:27], v2 offset:23552
  buffer_load_dwordx4 v[240:243], v135, s[48:51], s80 offen offset:0 sc1
  s_waitcnt vmcnt(13) lgkmcnt(6)
  v_mfma_f32_32x32x16_bf16 v[48:63], v[36:39], v[196:199], v[48:63]
  ds_read_b64_tr_b16 v[28:29], v3 offset:2048
  ds_read_b64_tr_b16 v[30:31], v3 offset:3072
  buffer_load_dwordx4 v[244:247], v135, s[48:51], s80 offen offset:1024 sc1
  s_waitcnt vmcnt(13) lgkmcnt(6)
  v_mfma_f32_32x32x16_bf16 v[48:63], v[16:19], v[200:203], v[48:63]
  ds_read_b64_tr_b16 v[32:33], v2 offset:32768
  ds_read_b64_tr_b16 v[34:35], v2 offset:33792
  buffer_load_dwordx4 v[248:251], v135, s[48:51], s80 offen offset:2048 sc1
  s_waitcnt lgkmcnt(6)
  v_mfma_f32_32x32x16_bf16 v[64:79], v[20:23], v[176:179], 0
  ds_read_b64_tr_b16 v[36:37], v3 offset:4096
  ds_read_b64_tr_b16 v[38:39], v3 offset:5120
  s_waitcnt vmcnt(13) lgkmcnt(6)
  v_mfma_f32_32x32x16_bf16 v[48:63], v[24:27], v[204:207], v[48:63]
  ds_read_b64_tr_b16 v[16:17], v2 offset:34816
  ds_read_b64_tr_b16 v[18:19], v2 offset:35840
  buffer_load_dwordx4 v[252:255], v135, s[48:51], s80 offen offset:3072 sc1
  s_waitcnt lgkmcnt(6)
  v_mfma_f32_32x32x16_bf16 v[64:79], v[28:31], v[180:183], v[64:79]
  ds_read_b64_tr_b16 v[20:21], v3 offset:6144
  ds_read_b64_tr_b16 v[22:23], v3 offset:7168
  s_waitcnt vmcnt(13) lgkmcnt(6)
  v_mfma_f32_32x32x16_bf16 v[48:63], v[32:35], v[208:211], v[48:63]
  ds_read_b64_tr_b16 v[24:25], v2 offset:36864
  ds_read_b64_tr_b16 v[26:27], v2 offset:37888
  buffer_load_dwordx4 v[176:179], v135, s[48:51], s81 offen offset:0 sc1
  s_waitcnt lgkmcnt(6)
  v_mfma_f32_32x32x16_bf16 v[64:79], v[36:39], v[184:187], v[64:79]
  ds_read_b64_tr_b16 v[28:29], v3 offset:16384
  ds_read_b64_tr_b16 v[30:31], v3 offset:17408
  s_waitcnt vmcnt(13) lgkmcnt(6)
  v_mfma_f32_32x32x16_bf16 v[48:63], v[16:19], v[212:215], v[48:63]
  ds_read_b64_tr_b16 v[32:33], v2 offset:38912
  ds_read_b64_tr_b16 v[34:35], v2 offset:39936
  buffer_load_dwordx4 v[180:183], v135, s[48:51], s81 offen offset:1024 sc1
  s_waitcnt lgkmcnt(6)
  v_mfma_f32_32x32x16_bf16 v[64:79], v[20:23], v[188:191], v[64:79]
  ds_read_b64_tr_b16 v[36:37], v3 offset:18432
  ds_read_b64_tr_b16 v[38:39], v3 offset:19456
  s_waitcnt vmcnt(13) lgkmcnt(6)
  v_mfma_f32_32x32x16_bf16 v[48:63], v[24:27], v[216:219], v[48:63]
  ds_read_b64_tr_b16 v[16:17], v2 offset:49152
  ds_read_b64_tr_b16 v[18:19], v2 offset:50176
  buffer_load_dwordx4 v[184:187], v135, s[48:51], s81 offen offset:2048 sc1
  s_waitcnt lgkmcnt(6)
  v_mfma_f32_32x32x16_bf16 v[64:79], v[28:31], v[192:195], v[64:79]
  ds_read_b64_tr_b16 v[20:21], v3 offset:20480
  ds_read_b64_tr_b16 v[22:23], v3 offset:21504
  s_waitcnt vmcnt(13) lgkmcnt(6)
  v_mfma_f32_32x32x16_bf16 v[48:63], v[32:35], v[220:223], v[48:63]
  ds_read_b64_tr_b16 v[24:25], v2 offset:51200
  ds_read_b64_tr_b16 v[26:27], v2 offset:52224
  buffer_load_dwordx4 v[188:191], v135, s[48:51], s81 offen offset:3072 sc1
  s_waitcnt lgkmcnt(6)
  v_mfma_f32_32x32x16_bf16 v[64:79], v[36:39], v[196:199], v[64:79]
  ds_read_b64_tr_b16 v[28:29], v3 offset:22528
  ds_read_b64_tr_b16 v[30:31], v3 offset:23552
  s_waitcnt vmcnt(13) lgkmcnt(6)
  v_mfma_f32_32x32x16_bf16 v[48:63], v[16:19], v[224:227], v[48:63]
  ds_read_b64_tr_b16 v[32:33], v2 offset:53248
  ds_read_b64_tr_b16 v[34:35], v2 offset:54272
  buffer_load_dwordx4 v[192:195], v135, s[48:51], s82 offen offset:0 sc1
  s_waitcnt lgkmcnt(6)
  v_mfma_f32_32x32x16_bf16 v[64:79], v[20:23], v[200:203], v[64:79]
  ds_read_b64_tr_b16 v[36:37], v3 offset:32768
  ds_read_b64_tr_b16 v[38:39], v3 offset:33792
  s_waitcnt vmcnt(11) lgkmcnt(6)
  v_mfma_f32_32x32x16_bf16 v[48:63], v[24:27], v[228:231], v[48:63]
  ds_read_b64_tr_b16 v[16:17], v2 offset:55296
  ds_read_b64_tr_b16 v[18:19], v2 offset:56320
  buffer_load_dwordx4 v[196:199], v135, s[48:51], s82 offen offset:1024 sc1
  s_waitcnt lgkmcnt(6)
  v_mfma_f32_32x32x16_bf16 v[64:79], v[28:31], v[204:207], v[64:79]
  ds_read_b64_tr_b16 v[20:21], v3 offset:34816
  ds_read_b64_tr_b16 v[22:23], v3 offset:35840
  s_waitcnt vmcnt(11) lgkmcnt(6)
  v_mfma_f32_32x32x16_bf16 v[48:63], v[32:35], v[232:235], v[48:63]
  ds_read_b64_tr_b16 v[24:25], v10 offset:0
  ds_read_b64_tr_b16 v[26:27], v10 offset:1024
  buffer_load_dwordx4 v[200:203], v135, s[48:51], s82 offen offset:2048 sc1
  s_waitcnt lgkmcnt(6)
  v_mfma_f32_32x32x16_bf16 v[64:79], v[36:39], v[208:211], v[64:79]
  ds_read_b64_tr_b16 v[28:29], v3 offset:36864
L_pad_62:
  s_cbranch_execz L_backB
  ds_read_b64_tr_b16 v[30:31], v3 offset:37888
  s_waitcnt vmcnt(11) lgkmcnt(6)
  v_mfma_f32_32x32x16_bf16 v[48:63], v[16:19], v[236:239], v[48:63]
  ds_read_b64_tr_b16 v[32:33], v10 offset:2048
  ds_read_b64_tr_b16 v[34:35], v10 offset:3072
  buffer_load_dwordx4 v[204:207], v135, s[48:51], s82 offen offset:3072 sc1
  s_waitcnt lgkmcnt(6)
  v_mfma_f32_32x32x16_bf16 v[64:79], v[20:23], v[212:215], v[64:79]
  ds_read_b64_tr_b16 v[36:37], v3 offset:38912
  ds_read_b64_tr_b16 v[38:39], v3 offset:39936
  s_waitcnt vmcnt(11) lgkmcnt(6)
  v_mfma_f32_32x32x16_bf16 v[48:63], v[24:27], v[240:243], v[48:63]
  ds_read_b64_tr_b16 v[16:17], v10 offset:4096
  ds_read_b64_tr_b16 v[18:19], v10 offset:5120
  s_waitcnt lgkmcnt(6)
  v_mfma_f32_32x32x16_bf16 v[64:79], v[28:31], v[216:219], v[64:79]
  ds_read_b64_tr_b16 v[20:21], v3 offset:49152
  ds_read_b64_tr_b16 v[22:23], v3 offset:50176
  s_waitcnt vmcnt(10) lgkmcnt(6)
  v_mfma_f32_32x32x16_bf16 v[48:63], v[32:35], v[244:247], v[48:63]
  ds_read_b64_tr_b16 v[24:25], v10 offset:6144
  ds_read_b64_tr_b16 v[26:27], v10 offset:7168
  s_waitcnt lgkmcnt(6)
  v_mfma_f32_32x32x16_bf16 v[64:79], v[36:39], v[220:223], v[64:79]
  ds_read_b64_tr_b16 v[28:29], v3 offset:51200
  ds_read_b64_tr_b16 v[30:31], v3 offset:52224
  s_waitcnt vmcnt(9) lgkmcnt(6)
  v_mfma_f32_32x32x16_bf16 v[48:63], v[16:19], v[248:251], v[48:63]
  ds_read_b64_tr_b16 v[32:33], v10 offset:16384
  ds_read_b64_tr_b16 v[34:35], v10 offset:17408
  s_waitcnt lgkmcnt(6)
  v_mfma_f32_32x32x16_bf16 v[64:79], v[20:23], v[224:227], v[64:79]
  ds_read_b64_tr_b16 v[36:37], v3 offset:53248
  ds_read_b64_tr_b16 v[38:39], v3 offset:54272
  s_waitcnt vmcnt(8) lgkmcnt(6)
  v_mfma_f32_32x32x16_bf16 v[48:63], v[24:27], v[252:255], v[48:63]
  ds_read_b64_tr_b16 v[16:17], v10 offset:18432
  ds_read_b64_tr_b16 v[18:19], v10 offset:19456
  s_waitcnt lgkmcnt(6)
  v_mfma_f32_32x32x16_bf16 v[64:79], v[28:31], v[228:231], v[64:79]
  ds_read_b64_tr_b16 v[20:21], v3 offset:55296
  ds_read_b64_tr_b16 v[22:23], v3 offset:56320
  s_waitcnt vmcnt(7) lgkmcnt(6)
  v_mfma_f32_32x32x16_bf16 v[48:63], v[32:35], v[176:179], v[48:63]
  ds_read_b64_tr_b16 v[24:25], v10 offset:20480
  ds_read_b64_tr_b16 v[26:27], v10 offset:21504
  s_waitcnt lgkmcnt(6)
  v_mfma_f32_32x32x16_bf16 v[64:79], v[36:39], v[232:235], v[64:79]
  ds_read_b64_tr_b16 v[28:29], v11 offset:0
  ds_read_b64_tr_b16 v[30:31], v11 offset:1024
  s_waitcnt vmcnt(6) lgkmcnt(6)
  v_mfma_f32_32x32x16_bf16 v[48:63], v[16:19], v[180:183], v[48:63]
  ds_read_b64_tr_b16 v[32:33], v10 offset:22528
  ds_read_b64_tr_b16 v[34:35], v10 offset:23552
  s_waitcnt lgkmcnt(6)
  v_mfma_f32_32x32x16_bf16 v[64:79], v[20:23], v[236:239], v[64:79]
  ds_read_b64_tr_b16 v[36:37], v11 offset:2048
  ds_read_b64_tr_b16 v[38:39], v11 offset:3072
  s_waitcnt vmcnt(5) lgkmcnt(6)
  v_mfma_f32_32x32x16_bf16 v[48:63], v[24:27], v[184:187], v[48:63]
  ds_read_b64_tr_b16 v[16:17], v10 offset:32768
  ds_read_b64_tr_b16 v[18:19], v10 offset:33792
  ds_read_b64_tr_b16 v[152:153], v8 offset:0
  ds_read_b64_tr_b16 v[154:155], v8 offset:512
  ds_read_b64_tr_b16 v[156:157], v8 offset:1024
  ds_read_b64_tr_b16 v[158:159], v8 offset:1536
  s_waitcnt lgkmcnt(10)
  v_mfma_f32_32x32x16_bf16 v[64:79], v[28:31], v[240:243], v[64:79]
  ds_read_b64_tr_b16 v[20:21], v11 offset:4096
  ds_read_b64_tr_b16 v[22:23], v11 offset:5120
  s_waitcnt vmcnt(4) lgkmcnt(10)
  v_mfma_f32_32x32x16_bf16 v[48:63], v[32:35], v[188:191], v[48:63]
  ds_read_b64_tr_b16 v[24:25], v10 offset:34816
  ds_read_b64_tr_b16 v[26:27], v10 offset:35840
  s_waitcnt lgkmcnt(7)
  v_pk_max_u16 v112, v152, v153
  s_waitcnt lgkmcnt(6)
  v_pk_max_u16 v113, v154, v155
  s_waitcnt lgkmcnt(5)
  v_pk_max_u16 v112, v112, v156
  v_pk_max_u16 v113, v113, v157
  s_waitcnt lgkmcnt(4)
  v_pk_max_u16 v112, v112, v158
  v_pk_max_u16 v113, v113, v159
  v_pk_max_u16 v112, v112, v113
  v_lshrrev_b32 v113, 16, v112
  v_max_u16 v112, v112, v113
  v_cmp_eq_u16 vcc, -1, v112
  s_nop 0
  s_cmp_eq_u64 vcc, 0
  s_cbranch_scc1 L_done_34
  s_movk_i32 s18, 4095
L_poll_35:
  s_sleep 2
  buffer_load_dwordx4 v14, s[48:51], s10 offen offset:0 sc1 lds
  buffer_load_dwordx4 v14, s[48:51], s10 offen offset:1024 sc1 lds
  s_waitcnt vmcnt(0)
  ds_read_b64_tr_b16 v[152:153], v8 offset:0
  ds_read_b64_tr_b16 v[154:155], v8 offset:512
  ds_read_b64_tr_b16 v[156:157], v8 offset:1024
  ds_read_b64_tr_b16 v[158:159], v8 offset:1536
  s_waitcnt lgkmcnt(0)
  s_waitcnt vmcnt(0)
  v_pk_max_u16 v112, v152, v153
  v_pk_max_u16 v113, v154, v155
  v_pk_max_u16 v112, v112, v156
  v_pk_max_u16 v113, v113, v157
  v_pk_max_u16 v112, v112, v158
  v_pk_max_u16 v113, v113, v159
  v_pk_max_u16 v112, v112, v113
  v_lshrrev_b32 v113, 16, v112
  v_max_u16 v112, v112, v113
  v_cmp_eq_u16 vcc, -1, v112
  s_nop 0
  s_cmp_eq_u64 vcc, 0
  s_cbranch_scc1 L_done_34
  s_sub_u32 s18, s18, 1
  s_cbranch_scc0 L_poll_35
L_done_34:
  v_lshlrev_b32 v144, 16, v152
  v_and_b32 v145, 0xffff0000, v152
  v_lshlrev_b32 v146, 16, v153
  v_and_b32 v147, 0xffff0000, v153
  v_lshlrev_b32 v148, 16, v154
  v_and_b32 v149, 0xffff0000, v154
  v_lshlrev_b32 v150, 16, v155
  v_and_b32 v151, 0xffff0000, v155
  v_lshlrev_b32 v152, 16, v156
  v_and_b32 v153, 0xffff0000, v156
  v_lshlrev_b32 v154, 16, v157
  v_and_b32 v155, 0xffff0000, v157
  v_lshlrev_b32 v156, 16, v158
  v_and_b32 v157, 0xffff0000, v158
  v_lshlrev_b32 v158, 16, v159
  v_and_b32 v159, 0xffff0000, v159
  buffer_load_dwordx4 v[168:171], v14, s[48:51], s6 offen offset:0 sc1
  buffer_load_dwordx4 v[172:175], v14, s[48:51], s6 offen offset:1024 sc1
  buffer_load_dword v120, v121, s[48:51], s6 offen offset:2048 sc1
  v_mfma_f32_32x32x16_bf16 v[64:79], v[36:39], v[244:247], v[64:79]
  ds_read_b64_tr_b16 v[28:29], v11 offset:6144
  ds_read_b64_tr_b16 v[30:31], v11 offset:7168
  v_mul_f32 v80, v80, v144
  v_mul_f32 v81, v81, v145
  v_mul_f32 v82, v82, v146
  v_mul_f32 v83, v83, v147
  s_waitcnt vmcnt(6)
  v_mfma_f32_32x32x16_bf16 v[48:63], v[16:19], v[192:195], v[48:63]
  ds_read_b64_tr_b16 v[32:33], v10 offset:36864
  ds_read_b64_tr_b16 v[34:35], v10 offset:37888
  v_mul_f32 v84, v84, v148
  v_mul_f32 v85, v85, v149
  v_mul_f32 v86, v86, v150
  v_mul_f32 v87, v87, v151
  s_waitcnt lgkmcnt(6)
  v_mfma_f32_32x32x16_bf16 v[64:79], v[20:23], v[248:251], v[64:79]
  ds_read_b64_tr_b16 v[36:37], v11 offset:16384
  ds_read_b64_tr_b16 v[38:39], v11 offset:17408
  v_mul_f32 v88, v88, v152
  v_mul_f32 v89, v89, v153
  v_mul_f32 v90, v90, v154
  v_mul_f32 v91, v91, v155
  s_waitcnt vmcnt(5) lgkmcnt(6)
  v_mfma_f32_32x32x16_bf16 v[48:63], v[24:27], v[196:199], v[48:63]
  ds_read_b64_tr_b16 v[16:17], v10 offset:38912
  ds_read_b64_tr_b16 v[18:19], v10 offset:39936
  v_mul_f32 v92, v92, v156
  v_mul_f32 v93, v93, v157
  v_mul_f32 v94, v94, v158
  v_mul_f32 v95, v95, v159
  s_waitcnt lgkmcnt(6)
  v_mfma_f32_32x32x16_bf16 v[64:79], v[28:31], v[252:255], v[64:79]
L_pad_63:
  s_cbranch_execz L_backB
  ds_read_b64_tr_b16 v[20:21], v11 offset:18432
  ds_read_b64_tr_b16 v[22:23], v11 offset:19456
  s_waitcnt vmcnt(4) lgkmcnt(6)
  v_mfma_f32_32x32x16_bf16 v[48:63], v[32:35], v[200:203], v[48:63]
  ds_read_b64_tr_b16 v[24:25], v11 offset:20480
  ds_read_b64_tr_b16 v[26:27], v11 offset:21504
  s_waitcnt lgkmcnt(6)
  v_mfma_f32_32x32x16_bf16 v[64:79], v[36:39], v[176:179], v[64:79]
  ds_read_b64_tr_b16 v[28:29], v11 offset:22528
  ds_read_b64_tr_b16 v[30:31], v11 offset:23552
  s_waitcnt vmcnt(3) lgkmcnt(6)
  v_mfma_f32_32x32x16_bf16 v[48:63], v[16:19], v[204:207], v[48:63]
  ds_read_b64_tr_b16 v[32:33], v11 offset:32768
  ds_read_b64_tr_b16 v[34:35], v11 offset:33792
  s_waitcnt lgkmcnt(6)
  v_mfma_f32_32x32x16_bf16 v[64:79], v[20:23], v[180:183], v[64:79]
  ds_read_b64_tr_b16 v[36:37], v11 offset:34816
  ds_read_b64_tr_b16 v[38:39], v11 offset:35840
  s_nop 5
  ds_write_b128 v4, v[48:51] offset:0
  ds_write_b128 v4, v[52:55] offset:1024
  ds_write_b128 v4, v[56:59] offset:2048
  ds_write_b128 v4, v[60:63] offset:3072
  s_waitcnt lgkmcnt(10)
  v_mfma_f32_32x32x16_bf16 v[64:79], v[24:27], v[184:187], v[64:79]
  ds_read_b64_tr_b16 v[16:17], v11 offset:36864
  ds_read_b64_tr_b16 v[18:19], v11 offset:37888
  s_waitcnt lgkmcnt(10)
  v_mfma_f32_32x32x16_bf16 v[64:79], v[28:31], v[188:191], v[64:79]
  ds_read_b64_tr_b16 v[20:21], v11 offset:38912
  ds_read_b64_tr_b16 v[22:23], v11 offset:39936
  s_waitcnt lgkmcnt(4)
  s_barrier
  ds_read_b128 v[144:147], v5 offset:0
  ds_read_b128 v[148:151], v5 offset:1024
  ds_read_b128 v[152:155], v5 offset:2048
  ds_read_b128 v[156:159], v5 offset:3072
  v_mfma_f32_32x32x16_bf16 v[64:79], v[32:35], v[192:195], v[64:79]
  s_waitcnt vmcnt(2)
  v_add3_u32 v112, v168, v169, s37
  v_add3_u32 v112, v170, v171, v112
  s_waitcnt vmcnt(1)
  v_add3_u32 v112, v172, v173, v112
  v_add3_u32 v112, v174, v175, v112
  s_waitcnt vmcnt(0)
  v_cmp_ne_u32 vcc, v120, v112
  s_nop 0
  s_cmp_eq_u64 vcc, 0
  s_cbranch_scc1 L_done_38
  s_movk_i32 s18, 4095
L_poll_39:
  s_sleep 2
  buffer_load_dwordx4 v[168:171], v14, s[48:51], s6 offen offset:0 sc1
  buffer_load_dwordx4 v[172:175], v14, s[48:51], s6 offen offset:1024 sc1
  buffer_load_dword v120, v121, s[48:51], s6 offen offset:2048 sc1
  s_waitcnt vmcnt(0)
  v_add3_u32 v112, v168, v169, s37
  v_add3_u32 v112, v170, v171, v112
  v_add3_u32 v112, v172, v173, v112
  v_add3_u32 v112, v174, v175, v112
  v_cmp_ne_u32 vcc, v120, v112
  s_nop 0
  s_cmp_eq_u64 vcc, 0
  s_cbranch_scc1 L_done_38
  s_sub_u32 s18, s18, 1
  s_cbranch_scc0 L_poll_39
L_done_38:
  v_lshlrev_b32 v160, 16, v168
  v_and_b32 v161, 0xffff0000, v168
  v_lshlrev_b32 v162, 16, v169
  v_and_b32 v163, 0xffff0000, v169
  v_lshlrev_b32 v164, 16, v170
  v_and_b32 v165, 0xffff0000, v170
  v_lshlrev_b32 v166, 16, v171
  v_and_b32 v167, 0xffff0000, v171
  v_lshlrev_b32 v168, 16, v172
  v_and_b32 v169, 0xffff0000, v172
  v_lshlrev_b32 v170, 16, v173
  v_and_b32 v171, 0xffff0000, v173
  v_lshlrev_b32 v172, 16, v174
  v_and_b32 v173, 0xffff0000, v174
  v_lshlrev_b32 v174, 16, v175
  v_and_b32 v175, 0xffff0000, v175
  s_waitcnt lgkmcnt(3)
  v_pk_add_f32 v[144:145], v[144:145], v[160:161]
  v_pk_add_f32 v[146:147], v[146:147], v[162:163]
  s_waitcnt lgkmcnt(2)
  v_pk_add_f32 v[148:149], v[148:149], v[164:165]
  v_pk_add_f32 v[150:151], v[150:151], v[166:167]
  v_mfma_f32_32x32x16_bf16 v[64:79], v[36:39], v[196:199], v[64:79]
  v_mfma_f32_32x32x16_bf16 v[64:79], v[16:19], v[200:203], v[64:79]
  s_waitcnt lgkmcnt(1)
  v_pk_add_f32 v[152:153], v[152:153], v[168:169]
  v_pk_add_f32 v[154:155], v[154:155], v[170:171]
  s_waitcnt lgkmcnt(0)
  v_pk_add_f32 v[156:157], v[156:157], v[172:173]
  v_pk_add_f32 v[158:159], v[158:159], v[174:175]
  v_mfma_f32_32x32x16_bf16 v[64:79], v[20:23], v[204:207], v[64:79]
  s_nop 11
  v_pk_add_f32 v[144:145], v[144:145], v[64:65]
  v_pk_add_f32 v[146:147], v[146:147], v[66:67]
  v_pk_add_f32 v[148:149], v[148:149], v[68:69]
  v_pk_add_f32 v[150:151], v[150:151], v[70:71]
  v_pk_mul_f32 v[160:161], v[144:145], v[114:115]
  v_pk_mul_f32 v[162:163], v[146:147], v[114:115]
  v_pk_mul_f32 v[164:165], v[148:149], v[114:115]
  v_pk_mul_f32 v[166:167], v[150:151], v[114:115]
  v_exp_f32 v160, v160
  v_exp_f32 v161, v161
  v_pk_mul_f32 v[144:145], v[144:145], v[80:81]
  v_exp_f32 v162, v162
  v_exp_f32 v163, v163
  v_pk_mul_f32 v[146:147], v[146:147], v[82:83]
  v_exp_f32 v164, v164
  v_exp_f32 v165, v165
  v_pk_mul_f32 v[148:149], v[148:149], v[84:85]
  v_exp_f32 v166, v166
  v_exp_f32 v167, v167
  v_pk_mul_f32 v[150:151], v[150:151], v[86:87]
  v_pk_add_f32 v[160:161], v[160:161], v[116:117]
  v_pk_add_f32 v[162:163], v[162:163], v[116:117]
  v_pk_add_f32 v[164:165], v[164:165], v[116:117]
  v_pk_add_f32 v[166:167], v[166:167], v[116:117]
  v_rcp_f32 v160, v160
  v_rcp_f32 v161, v161
  v_rcp_f32 v162, v162
  v_rcp_f32 v163, v163
  v_rcp_f32 v164, v164
  v_rcp_f32 v165, v165
  v_rcp_f32 v166, v166
  v_rcp_f32 v167, v167
  v_pk_fma_f32 v[144:145], v[144:145], v[160:161], v[96:97]
  v_pk_fma_f32 v[146:147], v[146:147], v[162:163], v[98:99]
  v_pk_fma_f32 v[148:149], v[148:149], v[164:165], v[100:101]
  v_pk_fma_f32 v[150:151], v[150:151], v[166:167], v[102:103]
  v_cvt_pk_bf16_f32 v16, v144, v145
  v_cvt_pk_bf16_f32 v17, v146, v147
  v_cvt_pk_bf16_f32 v18, v148, v149
  v_cvt_pk_bf16_f32 v19, v150, v151
  s_nop 0
  v_permlane32_swap_b32 v16, v18
  v_permlane32_swap_b32 v17, v19
  buffer_store_dwordx4 v[16:19], v143, s[56:59], s88 offen offset:0
  v_pk_add_f32 v[152:153], v[152:153], v[72:73]
  v_pk_add_f32 v[154:155], v[154:155], v[74:75]
  v_pk_add_f32 v[156:157], v[156:157], v[76:77]
  v_pk_add_f32 v[158:159], v[158:159], v[78:79]
  v_pk_mul_f32 v[168:169], v[152:153], v[114:115]
  v_pk_mul_f32 v[170:171], v[154:155], v[114:115]
  v_pk_mul_f32 v[172:173], v[156:157], v[114:115]
  v_pk_mul_f32 v[174:175], v[158:159], v[114:115]
  v_exp_f32 v168, v168
  v_exp_f32 v169, v169
  v_pk_mul_f32 v[152:153], v[152:153], v[88:89]
  v_exp_f32 v170, v170
  v_exp_f32 v171, v171
  v_pk_mul_f32 v[154:155], v[154:155], v[90:91]
  v_exp_f32 v172, v172
  v_exp_f32 v173, v173
  v_pk_mul_f32 v[156:157], v[156:157], v[92:93]
  v_exp_f32 v174, v174
  v_exp_f32 v175, v175
  v_pk_mul_f32 v[158:159], v[158:159], v[94:95]
  v_pk_add_f32 v[168:169], v[168:169], v[116:117]
  v_pk_add_f32 v[170:171], v[170:171], v[116:117]
  v_pk_add_f32 v[172:173], v[172:173], v[116:117]
  v_pk_add_f32 v[174:175], v[174:175], v[116:117]
  v_rcp_f32 v168, v168
  v_rcp_f32 v169, v169
  v_rcp_f32 v170, v170
  v_rcp_f32 v171, v171
  v_rcp_f32 v172, v172
  v_rcp_f32 v173, v173
L_pad_64:
  s_cbranch_execz L_backB
  v_rcp_f32 v174, v174
  v_rcp_f32 v175, v175
  v_pk_fma_f32 v[152:153], v[152:153], v[168:169], v[104:105]
  v_pk_fma_f32 v[154:155], v[154:155], v[170:171], v[106:107]
  v_pk_fma_f32 v[156:157], v[156:157], v[172:173], v[108:109]
  v_pk_fma_f32 v[158:159], v[158:159], v[174:175], v[110:111]
  v_cvt_pk_bf16_f32 v20, v152, v153
  v_cvt_pk_bf16_f32 v21, v154, v155
  v_cvt_pk_bf16_f32 v22, v156, v157
  v_cvt_pk_bf16_f32 v23, v158, v159
  s_nop 0
  v_permlane32_swap_b32 v20, v22
  v_permlane32_swap_b32 v21, v23
  buffer_store_dwordx4 v[20:23], v143, s[56:59], s88 offen offset:32
L_dump:
L_end:
  s_endpgm
L_spare:
  s_memrealtime s[10:11]
  s_load_dwordx2 s[44:45], s[0:1], 72
  s_load_dwordx2 s[64:65], s[0:1], 8
  s_load_dwordx2 s[68:69], s[0:1], 16
  s_load_dwordx2 s[72:73], s[0:1], 24
  s_mov_b32 s66, 2097152
  s_mov_b32 s67, 0x20000
  s_mov_b32 s70, 2097152
  s_mov_b32 s71, 0x20000
  s_mov_b32 s74, 4096
  s_mov_b32 s75, 0x20000
  s_lshl2_add_u32 s3, s21, s23
  v_lshlrev_b32 v14, 4, v1
  s_lshl3_add_u32 s8, s3, s20
  s_lshl_b32 s8, s8, 10
  s_add_u32 s8, s8, 12582912
  v_mov_b32 v48, -1
  v_mov_b32 v49, -1
  v_mov_b32 v50, -1
  v_mov_b32 v51, -1
  s_waitcnt lgkmcnt(0)
  buffer_store_dwordx4 v[48:51], v14, s[48:51], s8 offen sc1
  s_mul_i32 s9, s20, 1
  s_add_u32 s9, s9, s3
  s_and_b32 s9, s9, 31
  s_lshl_b32 s8, s9, 9
  s_add_u32 s8, s8, s20
  s_lshl_b32 s8, s8, 7
  v_and_b32 v4, 7, v1
  v_lshrrev_b32 v5, 3, v1
  v_lshl_add_u32 v3, v4, 4, s8
  v_lshl_add_u32 v3, v5, 13, v3
  v_subrev_u32 v2, 3072, v3
  v_xor_b32 v5, 7, v5
  v_lshlrev_b32 v5, 4, v5
  v_lshl_add_u32 v5, v4, 15, v5
  v_lshlrev_b32 v4, 6, v4
  s_lshl_b32 s12, s20, 9
  s_movk_i32 s14, 0x1000
  s_lshl_b32 s8, s20, 11
  s_sub_u32 s8, s8, s9
  s_lshl_b32 s8, s8, 7
  s_add_u32 s5, s8, 8392576
  s_getpc_b64 s[76:77]
L_pc_40:
  s_sub_u32 s76, s76, L_pc_40 - recurrent_scan__ssm_conv_h3__geglu_ffn__prompt_kernel
  s_subb_u32 s77, s77, 0
  s_mov_b32 s78, L_last - recurrent_scan__ssm_conv_h3__geglu_ffn__prompt_kernel
  s_mov_b32 s79, 0x20000
  v_lshlrev_b32 v255, 6, v0
  buffer_load_dword v255, v255, s[76:79], 0 offen
  buffer_load_dwordx4 v[156:159], v3, s[64:67], 0 offen offset:0 nt
  buffer_load_dwordx4 v[160:163], v3, s[64:67], 0 offen offset:1024 nt
  buffer_load_dwordx4 v[164:167], v3, s[64:67], 0 offen offset:2048 nt
  buffer_load_dwordx4 v[168:171], v3, s[64:67], 0 offen offset:3072 nt
  s_mov_b64 exec, 0
  s_cmp_eq_u32 s20, 0
  s_cbranch_scc1 L_pad_65
  s_cmp_eq_u32 s20, 1
  s_cbranch_scc1 L_pad_66
  s_cmp_eq_u32 s20, 2
  s_cbranch_scc1 L_pad_67
  s_cmp_eq_u32 s20, 3
  s_cbranch_scc1 L_pad_68
  s_cmp_eq_u32 s20, 4
  s_cbranch_scc1 L_pad_69
  s_cmp_eq_u32 s20, 5
  s_cbranch_scc1 L_backS
  s_cmp_eq_u32 s20, 6
  s_cbranch_scc1 L_backS
  s_cmp_eq_u32 s20, 7
  s_cbranch_scc1 L_backS
L_backS:
  s_mov_b64 exec, -1
  s_and_b32 s8, s3, 15
  s_and_b32 s4, s3, 16
  s_lshl1_add_u32 s4, s4, s8
  s_lshl_b32 s4, s4, 2
  s_lshl_b32 s3, s3, 5
  s_add_u32 s3, s3, 12615680
  s_cmp_eq_u32 s20, 0
  s_cselect_b32 s4, s4, 2130706432
  s_cselect_b32 s3, s3, 2130706432
  s_or_b32 s10, s10, 1
  v_mov_b32 v110, s10
  s_mov_b32 s62, 256
  s_mov_b32 s63, 0x20000
  s_waitcnt vmcnt(5)
  s_barrier
  s_mov_b64 exec, 1
  buffer_store_dword v110, off, s[60:63], s4 offset:0 sc1
  s_mov_b64 exec, -1
  buffer_load_dwordx4 v[172:175], v3, s[64:67], s14 offen offset:0 nt
  buffer_load_dwordx4 v[176:179], v3, s[64:67], s14 offen offset:1024 nt
  buffer_load_dwordx4 v[180:183], v3, s[64:67], s14 offen offset:2048 nt
  buffer_load_dwordx4 v[184:187], v3, s[64:67], s14 offen offset:3072 nt
  buffer_load_dwordx4 v[144:147], v2, s[64:67], 0 offen offset:0 nt
  buffer_load_dwordx4 v[148:151], v2, s[64:67], 0 offen offset:1024 nt
  buffer_load_dwordx4 v[152:155], v2, s[64:67], 0 offen offset:2048 nt
  buffer_load_dwordx4 v[220:223], v4, s[72:75], s12 offen offset:0
  buffer_load_dwordx4 v[224:227], v4, s[72:75], s12 offen offset:16
  buffer_load_dwordx4 v[228:231], v4, s[72:75], s12 offen offset:32
  buffer_load_dwordx4 v[232:235], v4, s[72:75], s12 offen offset:48
  buffer_load_dwordx4 v[188:191], v3, s[68:71], 0 offen offset:0 nt
  buffer_load_dwordx4 v[192:195], v3, s[68:71], 0 offen offset:1024 nt
  buffer_load_dwordx4 v[196:199], v3, s[68:71], 0 offen offset:2048 nt
  buffer_load_dwordx4 v[200:203], v3, s[68:71], 0 offen offset:3072 nt
  buffer_load_dwordx4 v[204:207], v3, s[68:71], s14 offen offset:0 nt
  buffer_load_dwordx4 v[208:211], v3, s[68:71], s14 offen offset:1024 nt
  buffer_load_dwordx4 v[212:215], v3, s[68:71], s14 offen offset:2048 nt
  buffer_load_dwordx4 v[216:219], v3, s[68:71], s14 offen offset:3072 nt
  s_lshl_b32 s9, s21, 5
  s_add_u32 s9, s9, s22
  s_lshl_b32 s8, s20, 11
  s_add_u32 s9, s9, s8
  s_lshl_b32 s9, s9, 7
  s_add_u32 s9, s9, 20971520
  v_lshrrev_b32 v6, 3, v1
  v_mul_u32_u24 v6, 32640, v6
  v_add_u32 v6, v6, v14
  buffer_store_dwordx4 v[48:51], v6, s[48:51], s9 offen sc1
  s_add_u32 s34, s30, 14
  s_mov_b32 s54, 2097152
  s_mov_b32 s55, 0x20000
  s_mov_b32 s58, 2097152
  s_mov_b32 s59, 0x20000
  s_mov_b32 s62, 256
  s_mov_b32 s63, 0x20000
  v_lshlrev_b32 v14, 4, v1
  s_and_b32 s90, s20, 3
  s_lshl_b32 s87, s21, 5
  s_add_u32 s87, s87, s22
  s_lshl_b32 s8, s87, 2
  s_load_dword s19, s[38:39], s8
  s_mul_i32 s8, s23, 2
  s_mul_i32 s9, s24, 1
  s_add_u32 s8, s8, s9
  s_mul_i32 s9, s31, 1
  s_add_u32 s8, s8, s9
  s_mul_i32 s9, s8, 37
  s_lshr_b32 s9, s9, 8
  s_mul_i32 s9, s9, 7
  s_sub_u32 s8, s8, s9
  s_lshl_b32 s76, s8, 12
  s_add_u32 s8, s76, 4096
  s_cmp_eq_u32 s8, 28672
  s_cselect_b32 s77, 0, s8
  s_add_u32 s8, s77, 4096
  s_cmp_eq_u32 s8, 28672
  s_cselect_b32 s78, 0, s8
  s_add_u32 s8, s78, 4096
  s_cmp_eq_u32 s8, 28672
  s_cselect_b32 s79, 0, s8
  s_add_u32 s8, s79, 4096
  s_cmp_eq_u32 s8, 28672
  s_cselect_b32 s80, 0, s8
  s_add_u32 s8, s80, 4096
  s_cmp_eq_u32 s8, 28672
  s_cselect_b32 s81, 0, s8
  s_add_u32 s8, s81, 4096
  s_cmp_eq_u32 s8, 28672
  s_cselect_b32 s82, 0, s8
  s_lshl1_add_u32 s8, s35, s27
  s_lshl1_add_u32 s9, s8, s30
  s_xor_b32 s8, s9, 1
  s_xor_b32 s89, s8, s29
  s_lshl1_add_u32 s10, s28, s29
  s_lshl2_add_u32 s11, s34, s10
  s_lshl_b32 s11, s11, 11
  s_mul_i32 s83, s8, 114688
  s_add_u32 s83, s83, s11
  s_mul_i32 s84, s9, 114688
  s_add_u32 s84, s84, s11
  s_lshl4_add_u32 s8, s8, s34
  s_lshl4_add_u32 s8, s8, s10
  s_lshl_b32 s8, s8, 2
  s_add_u32 s85, s8, 12648448
  s_xor_b32 s86, s85, 1024
  v_and_b32 v112, 15, v1
  v_lshrrev_b32 v113, 4, v1
  v_and_b32 v114, 1, v113
  v_lshlrev_b32 v129, 2, v112
  v_lshl_add_u32 v129, v114, 7, v129
  s_xor_b32 s8, s30, 1
  s_lshl_b32 s8, s8, 9
  v_and_b32 v115, 7, v1
  v_lshlrev_b32 v115, 3, v115
L_pad_65:
  s_cbranch_execz L_backS
  v_sub_u32 v115, v14, v115
  v_xor_b32 v130, s8, v115
  s_lshl1_add_u32 s9, s30, s28
  s_mul_i32 s8, s9, 14
  v_min_u32 v115, 13, v1
  v_add_u32 v115, s8, v115
  v_lshrrev_b32 v117, 2, v115
  v_and_b32 v115, 3, v115
  s_lshl_b32 s8, s89, 10
  s_add_u32 s8, s8, 12648448
  v_lshl_add_u32 v115, v115, 2, s8
  v_lshl_add_u32 v131, v117, 6, v115
  s_lshl2_add_u32 s8, s89, s9
  s_mul_i32 s8, s8, 28672
  v_add_u32 v135, s8, v14
  v_add3_u32 v142, v112, v113, -15
  s_mul_i32 s8, s29, 24576
  s_add_u32 s8, s8, 114688
  v_mul_u32_u24 v115, 4160, v114
  v_lshrrev_b32 v116, 1, v113
  v_mul_u32_u24 v117, 15488, v116
  v_add3_u32 v115, v115, v117, s8
  v_lshl_add_u32 v141, v112, 1, v115
  s_cmp_lt_u32 s20, 4
  s_cbranch_scc0 L_sc_41
  s_add_u32 s8, s24, 3
  s_and_b32 s8, s8, 3
  s_lshl2_add_u32 s8, s8, s90
  s_lshl_b32 s8, s8, 10
  s_add_u32 s8, s8, 49152
  v_add_u32 v15, s8, v14
  v_mov_b32 v134, 0
  s_branch L_sj_42
L_sc_41:
  v_lshrrev_b32 v115, 2, v1
  v_and_b32 v117, 3, v1
  v_and_b32 v118, 2, v115
  v_xor_b32 v117, v117, v118
  v_lshlrev_b32 v117, 4, v117
  v_lshl_add_u32 v117, v115, 7, v117
  s_lshr_b32 s8, s31, 1
  s_xor_b32 s8, s8, s23
  s_and_b32 s8, s8, 1
  s_lshl_b32 s8, s8, 6
  s_lshl2_add_u32 s9, s23, s90
  s_lshl_b32 s9, s9, 11
  s_add_u32 s8, s8, s9
  s_add_u32 s8, s8, 16384
  v_add_u32 v15, s8, v117
  s_mul_i32 s8, s28, 96
  s_add_u32 s8, s8, s27
  s_lshl_b32 s8, s8, 8
  s_add_u32 s8, s8, 114688
  v_and_b32 v115, 1, v1
  v_mul_u32_u24 v117, 4160, v115
  v_bfe_u32 v118, v1, 1, 1
  v_mul_u32_u24 v118, 15488, v118
  v_add3_u32 v117, v117, v118, s8
  v_lshl_add_u32 v117, v113, 4, v117
  v_bfe_u32 v118, v1, 2, 2
  v_lshl_add_u32 v132, v118, 3, v117
  s_add_u32 s8, s8, 10720
  v_lshl_add_u32 v117, v113, 4, s8
  v_lshlrev_b32 v118, 5, v112
  v_sub_u32 v133, v117, v118
  v_lshrrev_b32 v117, 1, v112
  v_lshlrev_b32 v117, 15, v117
  v_lshl_add_u32 v117, v115, 5, v117
  v_lshl_add_u32 v134, v113, 3, v117
  s_lshl_b32 s9, s28, 4
  s_waitcnt lgkmcnt(0)
  s_lshr_b32 s19, s19, s9
  s_and_b32 s19, s19, 0xffff
  s_cmp_eq_u32 s27, 0
  s_cselect_b32 s19, s19, 0
  v_lshl_add_u32 v117, v113, 3, v112
  v_sub_u32 v117, 15, v117
  v_and_b32 v118, 1, v117
  v_lshlrev_b32 v118, 4, v118
  v_lshlrev_b32 v118, v118, s19
  v_ashrrev_i32 v117, 1, v117
  v_cmp_eq_u32 vcc, 0, v117
  s_nop 1
  v_cndmask_b32 v136, 0, v118, vcc
  v_cmp_eq_u32 vcc, 1, v117
  s_nop 1
  v_cndmask_b32 v137, 0, v118, vcc
  v_cmp_eq_u32 vcc, 2, v117
  s_nop 1
  v_cndmask_b32 v138, 0, v118, vcc
  v_cmp_eq_u32 vcc, 3, v117
  s_nop 1
  v_cndmask_b32 v139, 0, v118, vcc
L_sj_42:
  s_nop 1
  s_waitcnt lgkmcnt(0)
  buffer_load_dword v128, v129, s[60:63], 0 offen offset:0 sc1
  s_lshl_b32 s91, s20, 10
  s_mul_i32 s8, s30, 112
  s_add_u32 s8, s8, s20
  s_lshl_b32 s8, s8, 6
  s_add_u32 s8, s8, s24
  s_lshl_b32 s8, s8, 7
  v_lshrrev_b32 v116, 3, v1
  v_lshrrev_b32 v117, 2, v1
  v_and_b32 v117, 4, v117
  v_and_b32 v0, 7, v1
  v_xor_b32 v0, v0, v117
  v_lshl_add_u32 v0, v0, 4, s8
  v_lshl_add_u32 v0, v116, 10, v0
  v_mov_b32 v6, 0
  v_mov_b32 v7, 0
  s_waitcnt vmcnt(13)
  v_lshlrev_b32 v48, 16, v220
  v_lshlrev_b32 v49, 16, v222
  v_and_b32 v50, 0xffff0000, v220
  v_and_b32 v51, 0xffff0000, v222
  v_lshlrev_b32 v52, 16, v221
  v_lshlrev_b32 v53, 16, v223
  v_and_b32 v54, 0xffff0000, v221
  v_and_b32 v55, 0xffff0000, v223
  v_lshlrev_b32 v56, 16, v144
  v_and_b32 v57, 0xffff0000, v144
  v_lshlrev_b32 v58, 16, v148
  v_and_b32 v59, 0xffff0000, v148
  v_lshlrev_b32 v60, 16, v152
  v_and_b32 v61, 0xffff0000, v152
  v_lshlrev_b32 v62, 16, v156
  v_and_b32 v63, 0xffff0000, v156
  v_lshlrev_b32 v64, 16, v160
  v_and_b32 v65, 0xffff0000, v160
  v_lshlrev_b32 v66, 16, v164
  v_and_b32 v67, 0xffff0000, v164
  v_lshlrev_b32 v68, 16, v168
  v_and_b32 v69, 0xffff0000, v168
  v_lshlrev_b32 v70, 16, v172
  v_and_b32 v71, 0xffff0000, v172
  v_lshlrev_b32 v72, 16, v176
  v_and_b32 v73, 0xffff0000, v176
  v_lshlrev_b32 v74, 16, v180
  v_and_b32 v75, 0xffff0000, v180
  v_lshlrev_b32 v76, 16, v184
  v_and_b32 v77, 0xffff0000, v184
  v_pk_mul_f32 v[78:79], v[62:63], v[48:49]
  v_pk_mul_f32 v[80:81], v[64:65], v[48:49]
  v_pk_mul_f32 v[82:83], v[66:67], v[48:49]
  v_pk_mul_f32 v[84:85], v[68:69], v[48:49]
  v_pk_mul_f32 v[86:87], v[70:71], v[48:49]
  v_pk_mul_f32 v[88:89], v[72:73], v[48:49]
  v_pk_mul_f32 v[90:91], v[74:75], v[48:49]
  v_pk_mul_f32 v[92:93], v[76:77], v[48:49]
  v_pk_fma_f32 v[78:79], v[60:61], v[50:51], v[78:79]
  v_pk_fma_f32 v[80:81], v[62:63], v[50:51], v[80:81]
  v_pk_fma_f32 v[82:83], v[64:65], v[50:51], v[82:83]
  v_pk_fma_f32 v[84:85], v[66:67], v[50:51], v[84:85]
  v_pk_fma_f32 v[86:87], v[68:69], v[50:51], v[86:87]
  v_pk_fma_f32 v[88:89], v[70:71], v[50:51], v[88:89]
  v_pk_fma_f32 v[90:91], v[72:73], v[50:51], v[90:91]
  v_pk_fma_f32 v[92:93], v[74:75], v[50:51], v[92:93]
  v_pk_fma_f32 v[78:79], v[58:59], v[52:53], v[78:79]
  v_pk_fma_f32 v[80:81], v[60:61], v[52:53], v[80:81]
  v_pk_fma_f32 v[82:83], v[62:63], v[52:53], v[82:83]
  v_pk_fma_f32 v[84:85], v[64:65], v[52:53], v[84:85]
  v_pk_fma_f32 v[86:87], v[66:67], v[52:53], v[86:87]
  v_pk_fma_f32 v[88:89], v[68:69], v[52:53], v[88:89]
  v_pk_fma_f32 v[90:91], v[70:71], v[52:53], v[90:91]
  v_pk_fma_f32 v[92:93], v[72:73], v[52:53], v[92:93]
  v_pk_fma_f32 v[78:79], v[56:57], v[54:55], v[78:79]
  v_pk_fma_f32 v[80:81], v[58:59], v[54:55], v[80:81]
  v_pk_fma_f32 v[82:83], v[60:61], v[54:55], v[82:83]
  v_pk_fma_f32 v[84:85], v[62:63], v[54:55], v[84:85]
  v_pk_fma_f32 v[86:87], v[64:65], v[54:55], v[86:87]
  v_pk_fma_f32 v[88:89], v[66:67], v[54:55], v[88:89]
  v_pk_fma_f32 v[90:91], v[68:69], v[54:55], v[90:91]
  v_pk_fma_f32 v[92:93], v[70:71], v[54:55], v[92:93]
  s_waitcnt vmcnt(9)
  v_lshlrev_b32 v94, 16, v188
  v_and_b32 v95, 0xffff0000, v188
  s_waitcnt vmcnt(8)
  v_lshlrev_b32 v96, 16, v192
  v_and_b32 v97, 0xffff0000, v192
  s_waitcnt vmcnt(7)
  v_lshlrev_b32 v98, 16, v196
  v_and_b32 v99, 0xffff0000, v196
  s_waitcnt vmcnt(6)
  v_lshlrev_b32 v100, 16, v200
  v_and_b32 v101, 0xffff0000, v200
  s_waitcnt vmcnt(5)
L_pad_66:
  s_cbranch_execz L_backS
  v_lshlrev_b32 v102, 16, v204
  v_and_b32 v103, 0xffff0000, v204
  s_waitcnt vmcnt(4)
  v_lshlrev_b32 v104, 16, v208
  v_and_b32 v105, 0xffff0000, v208
  s_waitcnt vmcnt(3)
  v_lshlrev_b32 v106, 16, v212
  v_and_b32 v107, 0xffff0000, v212
  s_waitcnt vmcnt(2)
  v_lshlrev_b32 v108, 16, v216
  v_and_b32 v109, 0xffff0000, v216
  v_pk_mul_f32 v[78:79], v[78:79], v[94:95]
  v_pk_mul_f32 v[80:81], v[80:81], v[96:97]
  v_pk_mul_f32 v[82:83], v[82:83], v[98:99]
  v_pk_mul_f32 v[84:85], v[84:85], v[100:101]
  v_pk_mul_f32 v[86:87], v[86:87], v[102:103]
  v_pk_mul_f32 v[88:89], v[88:89], v[104:105]
  v_pk_mul_f32 v[90:91], v[90:91], v[106:107]
  v_pk_mul_f32 v[92:93], v[92:93], v[108:109]
  v_cvt_pk_bf16_f32 v236, v92, v90
  v_cvt_pk_bf16_f32 v237, v88, v86
  v_cvt_pk_bf16_f32 v238, v84, v82
  v_cvt_pk_bf16_f32 v239, v80, v78
  buffer_store_dwordx4 v[236:239], v5, s[48:51], s5 offen sc1
  s_add_u32 s5, s5, 4096
  v_cvt_pk_bf16_f32 v240, v93, v91
  v_cvt_pk_bf16_f32 v241, v89, v87
  v_cvt_pk_bf16_f32 v242, v85, v83
  v_cvt_pk_bf16_f32 v243, v81, v79
  buffer_store_dwordx4 v[240:243], v5, s[48:51], s5 offen sc1
  s_add_u32 s5, s5, 4096
  v_lshlrev_b32 v48, 16, v224
  v_lshlrev_b32 v49, 16, v226
  v_and_b32 v50, 0xffff0000, v224
  v_and_b32 v51, 0xffff0000, v226
  v_lshlrev_b32 v52, 16, v225
  v_lshlrev_b32 v53, 16, v227
  v_and_b32 v54, 0xffff0000, v225
  v_and_b32 v55, 0xffff0000, v227
  v_lshlrev_b32 v56, 16, v145
  v_and_b32 v57, 0xffff0000, v145
  v_lshlrev_b32 v58, 16, v149
  v_and_b32 v59, 0xffff0000, v149
  v_lshlrev_b32 v60, 16, v153
  v_and_b32 v61, 0xffff0000, v153
  v_lshlrev_b32 v62, 16, v157
  v_and_b32 v63, 0xffff0000, v157
  v_lshlrev_b32 v64, 16, v161
  v_and_b32 v65, 0xffff0000, v161
  v_lshlrev_b32 v66, 16, v165
  v_and_b32 v67, 0xffff0000, v165
  v_lshlrev_b32 v68, 16, v169
  v_and_b32 v69, 0xffff0000, v169
  v_lshlrev_b32 v70, 16, v173
  v_and_b32 v71, 0xffff0000, v173
  v_lshlrev_b32 v72, 16, v177
  v_and_b32 v73, 0xffff0000, v177
  v_lshlrev_b32 v74, 16, v181
  v_and_b32 v75, 0xffff0000, v181
  v_lshlrev_b32 v76, 16, v185
  v_and_b32 v77, 0xffff0000, v185
  v_pk_mul_f32 v[78:79], v[62:63], v[48:49]
  v_pk_mul_f32 v[80:81], v[64:65], v[48:49]
  v_pk_mul_f32 v[82:83], v[66:67], v[48:49]
  v_pk_mul_f32 v[84:85], v[68:69], v[48:49]
  v_pk_mul_f32 v[86:87], v[70:71], v[48:49]
  v_pk_mul_f32 v[88:89], v[72:73], v[48:49]
  v_pk_mul_f32 v[90:91], v[74:75], v[48:49]
  v_pk_mul_f32 v[92:93], v[76:77], v[48:49]
  v_pk_fma_f32 v[78:79], v[60:61], v[50:51], v[78:79]
  v_pk_fma_f32 v[80:81], v[62:63], v[50:51], v[80:81]
  v_pk_fma_f32 v[82:83], v[64:65], v[50:51], v[82:83]
  v_pk_fma_f32 v[84:85], v[66:67], v[50:51], v[84:85]
  v_pk_fma_f32 v[86:87], v[68:69], v[50:51], v[86:87]
  v_pk_fma_f32 v[88:89], v[70:71], v[50:51], v[88:89]
  v_pk_fma_f32 v[90:91], v[72:73], v[50:51], v[90:91]
  v_pk_fma_f32 v[92:93], v[74:75], v[50:51], v[92:93]
  v_pk_fma_f32 v[78:79], v[58:59], v[52:53], v[78:79]
  v_pk_fma_f32 v[80:81], v[60:61], v[52:53], v[80:81]
  v_pk_fma_f32 v[82:83], v[62:63], v[52:53], v[82:83]
  v_pk_fma_f32 v[84:85], v[64:65], v[52:53], v[84:85]
  v_pk_fma_f32 v[86:87], v[66:67], v[52:53], v[86:87]
  v_pk_fma_f32 v[88:89], v[68:69], v[52:53], v[88:89]
  v_pk_fma_f32 v[90:91], v[70:71], v[52:53], v[90:91]
  v_pk_fma_f32 v[92:93], v[72:73], v[52:53], v[92:93]
  v_pk_fma_f32 v[78:79], v[56:57], v[54:55], v[78:79]
  v_pk_fma_f32 v[80:81], v[58:59], v[54:55], v[80:81]
  v_pk_fma_f32 v[82:83], v[60:61], v[54:55], v[82:83]
  v_pk_fma_f32 v[84:85], v[62:63], v[54:55], v[84:85]
  v_pk_fma_f32 v[86:87], v[64:65], v[54:55], v[86:87]
  v_pk_fma_f32 v[88:89], v[66:67], v[54:55], v[88:89]
  v_pk_fma_f32 v[90:91], v[68:69], v[54:55], v[90:91]
  v_pk_fma_f32 v[92:93], v[70:71], v[54:55], v[92:93]
  v_lshlrev_b32 v94, 16, v189
  v_and_b32 v95, 0xffff0000, v189
  v_lshlrev_b32 v96, 16, v193
  v_and_b32 v97, 0xffff0000, v193
  v_lshlrev_b32 v98, 16, v197
  v_and_b32 v99, 0xffff0000, v197
  v_lshlrev_b32 v100, 16, v201
  v_and_b32 v101, 0xffff0000, v201
  v_lshlrev_b32 v102, 16, v205
  v_and_b32 v103, 0xffff0000, v205
  v_lshlrev_b32 v104, 16, v209
  v_and_b32 v105, 0xffff0000, v209
  v_lshlrev_b32 v106, 16, v213
  v_and_b32 v107, 0xffff0000, v213
  v_lshlrev_b32 v108, 16, v217
  v_and_b32 v109, 0xffff0000, v217
  v_pk_mul_f32 v[78:79], v[78:79], v[94:95]
  v_pk_mul_f32 v[80:81], v[80:81], v[96:97]
  v_pk_mul_f32 v[82:83], v[82:83], v[98:99]
  v_pk_mul_f32 v[84:85], v[84:85], v[100:101]
  v_pk_mul_f32 v[86:87], v[86:87], v[102:103]
  v_pk_mul_f32 v[88:89], v[88:89], v[104:105]
  v_pk_mul_f32 v[90:91], v[90:91], v[106:107]
  v_pk_mul_f32 v[92:93], v[92:93], v[108:109]
  v_cvt_pk_bf16_f32 v244, v92, v90
  v_cvt_pk_bf16_f32 v245, v88, v86
  v_cvt_pk_bf16_f32 v246, v84, v82
  v_cvt_pk_bf16_f32 v247, v80, v78
  buffer_store_dwordx4 v[244:247], v5, s[48:51], s5 offen sc1
  s_add_u32 s5, s5, 4096
  v_cvt_pk_bf16_f32 v248, v93, v91
  v_cvt_pk_bf16_f32 v249, v89, v87
  v_cvt_pk_bf16_f32 v250, v85, v83
  v_cvt_pk_bf16_f32 v251, v81, v79
  buffer_store_dwordx4 v[248:251], v5, s[48:51], s5 offen sc1
  s_add_u32 s5, s5, 4096
  v_lshlrev_b32 v48, 16, v228
  v_lshlrev_b32 v49, 16, v230
  v_and_b32 v50, 0xffff0000, v228
  v_and_b32 v51, 0xffff0000, v230
  v_lshlrev_b32 v52, 16, v229
  v_lshlrev_b32 v53, 16, v231
  v_and_b32 v54, 0xffff0000, v229
  v_and_b32 v55, 0xffff0000, v231
  v_lshlrev_b32 v56, 16, v146
  v_and_b32 v57, 0xffff0000, v146
  v_lshlrev_b32 v58, 16, v150
  v_and_b32 v59, 0xffff0000, v150
  v_lshlrev_b32 v60, 16, v154
  v_and_b32 v61, 0xffff0000, v154
  v_lshlrev_b32 v62, 16, v158
  v_and_b32 v63, 0xffff0000, v158
  v_lshlrev_b32 v64, 16, v162
  v_and_b32 v65, 0xffff0000, v162
  v_lshlrev_b32 v66, 16, v166
  v_and_b32 v67, 0xffff0000, v166
  v_lshlrev_b32 v68, 16, v170
  v_and_b32 v69, 0xffff0000, v170
  v_lshlrev_b32 v70, 16, v174
  v_and_b32 v71, 0xffff0000, v174
  v_lshlrev_b32 v72, 16, v178
  v_and_b32 v73, 0xffff0000, v178
  v_lshlrev_b32 v74, 16, v182
  v_and_b32 v75, 0xffff0000, v182
  v_lshlrev_b32 v76, 16, v186
L_pad_67:
  s_cbranch_execz L_backS
  v_and_b32 v77, 0xffff0000, v186
  v_pk_mul_f32 v[78:79], v[62:63], v[48:49]
  v_pk_mul_f32 v[80:81], v[64:65], v[48:49]
  v_pk_mul_f32 v[82:83], v[66:67], v[48:49]
  v_pk_mul_f32 v[84:85], v[68:69], v[48:49]
  v_pk_mul_f32 v[86:87], v[70:71], v[48:49]
  v_pk_mul_f32 v[88:89], v[72:73], v[48:49]
  v_pk_mul_f32 v[90:91], v[74:75], v[48:49]
  v_pk_mul_f32 v[92:93], v[76:77], v[48:49]
  v_pk_fma_f32 v[78:79], v[60:61], v[50:51], v[78:79]
  v_pk_fma_f32 v[80:81], v[62:63], v[50:51], v[80:81]
  v_pk_fma_f32 v[82:83], v[64:65], v[50:51], v[82:83]
  v_pk_fma_f32 v[84:85], v[66:67], v[50:51], v[84:85]
  v_pk_fma_f32 v[86:87], v[68:69], v[50:51], v[86:87]
  v_pk_fma_f32 v[88:89], v[70:71], v[50:51], v[88:89]
  v_pk_fma_f32 v[90:91], v[72:73], v[50:51], v[90:91]
  v_pk_fma_f32 v[92:93], v[74:75], v[50:51], v[92:93]
  v_pk_fma_f32 v[78:79], v[58:59], v[52:53], v[78:79]
  v_pk_fma_f32 v[80:81], v[60:61], v[52:53], v[80:81]
  v_pk_fma_f32 v[82:83], v[62:63], v[52:53], v[82:83]
  v_pk_fma_f32 v[84:85], v[64:65], v[52:53], v[84:85]
  v_pk_fma_f32 v[86:87], v[66:67], v[52:53], v[86:87]
  v_pk_fma_f32 v[88:89], v[68:69], v[52:53], v[88:89]
  v_pk_fma_f32 v[90:91], v[70:71], v[52:53], v[90:91]
  v_pk_fma_f32 v[92:93], v[72:73], v[52:53], v[92:93]
  v_pk_fma_f32 v[78:79], v[56:57], v[54:55], v[78:79]
  v_pk_fma_f32 v[80:81], v[58:59], v[54:55], v[80:81]
  v_pk_fma_f32 v[82:83], v[60:61], v[54:55], v[82:83]
  v_pk_fma_f32 v[84:85], v[62:63], v[54:55], v[84:85]
  v_pk_fma_f32 v[86:87], v[64:65], v[54:55], v[86:87]
  v_pk_fma_f32 v[88:89], v[66:67], v[54:55], v[88:89]
  v_pk_fma_f32 v[90:91], v[68:69], v[54:55], v[90:91]
  v_pk_fma_f32 v[92:93], v[70:71], v[54:55], v[92:93]
  v_lshlrev_b32 v94, 16, v190
  v_and_b32 v95, 0xffff0000, v190
  v_lshlrev_b32 v96, 16, v194
  v_and_b32 v97, 0xffff0000, v194
  v_lshlrev_b32 v98, 16, v198
  v_and_b32 v99, 0xffff0000, v198
  v_lshlrev_b32 v100, 16, v202
  v_and_b32 v101, 0xffff0000, v202
  v_lshlrev_b32 v102, 16, v206
  v_and_b32 v103, 0xffff0000, v206
  v_lshlrev_b32 v104, 16, v210
  v_and_b32 v105, 0xffff0000, v210
  v_lshlrev_b32 v106, 16, v214
  v_and_b32 v107, 0xffff0000, v214
  v_lshlrev_b32 v108, 16, v218
  v_and_b32 v109, 0xffff0000, v218
  v_pk_mul_f32 v[78:79], v[78:79], v[94:95]
  v_pk_mul_f32 v[80:81], v[80:81], v[96:97]
  v_pk_mul_f32 v[82:83], v[82:83], v[98:99]
  v_pk_mul_f32 v[84:85], v[84:85], v[100:101]
  v_pk_mul_f32 v[86:87], v[86:87], v[102:103]
  v_pk_mul_f32 v[88:89], v[88:89], v[104:105]
  v_pk_mul_f32 v[90:91], v[90:91], v[106:107]
  v_pk_mul_f32 v[92:93], v[92:93], v[108:109]
  v_cvt_pk_bf16_f32 v236, v92, v90
  v_cvt_pk_bf16_f32 v237, v88, v86
  v_cvt_pk_bf16_f32 v238, v84, v82
  v_cvt_pk_bf16_f32 v239, v80, v78
  buffer_store_dwordx4 v[236:239], v5, s[48:51], s5 offen sc1
  s_add_u32 s5, s5, 4096
  v_cvt_pk_bf16_f32 v240, v93, v91
  v_cvt_pk_bf16_f32 v241, v89, v87
  v_cvt_pk_bf16_f32 v242, v85, v83
  v_cvt_pk_bf16_f32 v243, v81, v79
  buffer_store_dwordx4 v[240:243], v5, s[48:51], s5 offen sc1
  s_add_u32 s5, s5, 4096
  v_lshlrev_b32 v48, 16, v232
  v_lshlrev_b32 v49, 16, v234
  v_and_b32 v50, 0xffff0000, v232
  v_and_b32 v51, 0xffff0000, v234
  v_lshlrev_b32 v52, 16, v233
  v_lshlrev_b32 v53, 16, v235
  v_and_b32 v54, 0xffff0000, v233
  v_and_b32 v55, 0xffff0000, v235
  v_lshlrev_b32 v56, 16, v147
  v_and_b32 v57, 0xffff0000, v147
  v_lshlrev_b32 v58, 16, v151
  v_and_b32 v59, 0xffff0000, v151
  v_lshlrev_b32 v60, 16, v155
  v_and_b32 v61, 0xffff0000, v155
  v_lshlrev_b32 v62, 16, v159
  v_and_b32 v63, 0xffff0000, v159
  v_lshlrev_b32 v64, 16, v163
  v_and_b32 v65, 0xffff0000, v163
  v_lshlrev_b32 v66, 16, v167
  v_and_b32 v67, 0xffff0000, v167
  v_lshlrev_b32 v68, 16, v171
  v_and_b32 v69, 0xffff0000, v171
  v_lshlrev_b32 v70, 16, v175
  v_and_b32 v71, 0xffff0000, v175
  v_lshlrev_b32 v72, 16, v179
  v_and_b32 v73, 0xffff0000, v179
  v_lshlrev_b32 v74, 16, v183
  v_and_b32 v75, 0xffff0000, v183
  v_lshlrev_b32 v76, 16, v187
  v_and_b32 v77, 0xffff0000, v187
  v_pk_mul_f32 v[78:79], v[62:63], v[48:49]
  v_pk_mul_f32 v[80:81], v[64:65], v[48:49]
  v_pk_mul_f32 v[82:83], v[66:67], v[48:49]
  v_pk_mul_f32 v[84:85], v[68:69], v[48:49]
  v_pk_mul_f32 v[86:87], v[70:71], v[48:49]
  v_pk_mul_f32 v[88:89], v[72:73], v[48:49]
  v_pk_mul_f32 v[90:91], v[74:75], v[48:49]
  v_pk_mul_f32 v[92:93], v[76:77], v[48:49]
  v_pk_fma_f32 v[78:79], v[60:61], v[50:51], v[78:79]
  v_pk_fma_f32 v[80:81], v[62:63], v[50:51], v[80:81]
  v_pk_fma_f32 v[82:83], v[64:65], v[50:51], v[82:83]
  v_pk_fma_f32 v[84:85], v[66:67], v[50:51], v[84:85]
  v_pk_fma_f32 v[86:87], v[68:69], v[50:51], v[86:87]
  v_pk_fma_f32 v[88:89], v[70:71], v[50:51], v[88:89]
  v_pk_fma_f32 v[90:91], v[72:73], v[50:51], v[90:91]
  v_pk_fma_f32 v[92:93], v[74:75], v[50:51], v[92:93]
  v_pk_fma_f32 v[78:79], v[58:59], v[52:53], v[78:79]
  v_pk_fma_f32 v[80:81], v[60:61], v[52:53], v[80:81]
  v_pk_fma_f32 v[82:83], v[62:63], v[52:53], v[82:83]
  v_pk_fma_f32 v[84:85], v[64:65], v[52:53], v[84:85]
  v_pk_fma_f32 v[86:87], v[66:67], v[52:53], v[86:87]
  v_pk_fma_f32 v[88:89], v[68:69], v[52:53], v[88:89]
  v_pk_fma_f32 v[90:91], v[70:71], v[52:53], v[90:91]
  v_pk_fma_f32 v[92:93], v[72:73], v[52:53], v[92:93]
  v_pk_fma_f32 v[78:79], v[56:57], v[54:55], v[78:79]
  v_pk_fma_f32 v[80:81], v[58:59], v[54:55], v[80:81]
  v_pk_fma_f32 v[82:83], v[60:61], v[54:55], v[82:83]
  v_pk_fma_f32 v[84:85], v[62:63], v[54:55], v[84:85]
  v_pk_fma_f32 v[86:87], v[64:65], v[54:55], v[86:87]
  v_pk_fma_f32 v[88:89], v[66:67], v[54:55], v[88:89]
  v_pk_fma_f32 v[90:91], v[68:69], v[54:55], v[90:91]
  v_pk_fma_f32 v[92:93], v[70:71], v[54:55], v[92:93]
  v_lshlrev_b32 v94, 16, v191
  v_and_b32 v95, 0xffff0000, v191
  v_lshlrev_b32 v96, 16, v195
  v_and_b32 v97, 0xffff0000, v195
  v_lshlrev_b32 v98, 16, v199
  v_and_b32 v99, 0xffff0000, v199
  v_lshlrev_b32 v100, 16, v203
  v_and_b32 v101, 0xffff0000, v203
  v_lshlrev_b32 v102, 16, v207
  v_and_b32 v103, 0xffff0000, v207
  v_lshlrev_b32 v104, 16, v211
  v_and_b32 v105, 0xffff0000, v211
  v_lshlrev_b32 v106, 16, v215
  v_and_b32 v107, 0xffff0000, v215
  v_lshlrev_b32 v108, 16, v219
  v_and_b32 v109, 0xffff0000, v219
  v_pk_mul_f32 v[78:79], v[78:79], v[94:95]
  v_pk_mul_f32 v[80:81], v[80:81], v[96:97]
  v_pk_mul_f32 v[82:83], v[82:83], v[98:99]
  v_pk_mul_f32 v[84:85], v[84:85], v[100:101]
L_pad_68:
  s_cbranch_execz L_backS
  v_pk_mul_f32 v[86:87], v[86:87], v[102:103]
  v_pk_mul_f32 v[88:89], v[88:89], v[104:105]
  v_pk_mul_f32 v[90:91], v[90:91], v[106:107]
  v_pk_mul_f32 v[92:93], v[92:93], v[108:109]
  v_cvt_pk_bf16_f32 v244, v92, v90
  v_cvt_pk_bf16_f32 v245, v88, v86
  v_cvt_pk_bf16_f32 v246, v84, v82
  v_cvt_pk_bf16_f32 v247, v80, v78
  buffer_store_dwordx4 v[244:247], v5, s[48:51], s5 offen sc1
  s_add_u32 s5, s5, 4096
  v_cvt_pk_bf16_f32 v248, v93, v91
  v_cvt_pk_bf16_f32 v249, v89, v87
  v_cvt_pk_bf16_f32 v250, v85, v83
  v_cvt_pk_bf16_f32 v251, v81, v79
  buffer_store_dwordx4 v[248:251], v5, s[48:51], s5 offen sc1
  s_add_u32 s5, s5, 4096
  s_waitcnt vmcnt(8)
  v_cmp_ne_u32 vcc, 0, v128
  s_nop 0
  s_cmp_eq_u64 vcc, -1
  s_cbranch_scc1 L_done_43
  s_movk_i32 s18, 4095
L_poll_44:
  s_sleep 2
  buffer_load_dword v128, v129, s[60:63], 0 offen offset:0 sc1
  s_waitcnt vmcnt(0)
  v_cmp_ne_u32 vcc, 0, v128
  s_nop 0
  s_cmp_eq_u64 vcc, -1
  s_cbranch_scc1 L_done_43
  s_sub_u32 s18, s18, 1
  s_cbranch_scc0 L_poll_44
L_done_43:
  v_readfirstlane_b32 s19, v128
  s_nop 0
  s_mov_b32 s37, s19
  v_and_b32 v15, 3, v1
  v_lshlrev_b32 v15, 3, v15
  v_bfe_u32 v15, s19, v15, 8
  s_bfe_u32 s25, s19, 524296
  s_bfe_u32 s26, s19, 524304
  s_bfe_u32 s32, s19, 524312
  s_bfe_u32 s19, s19, 524288
  s_waitcnt vmcnt(0)
  s_barrier
  v_mov_b32 v113, 1
  s_mov_b64 exec, 1
  buffer_store_dword v113, off, s[48:51], s3 sc1
  s_mov_b64 exec, -1
  s_lshl1_add_u32 s13, s87, s29
  s_lshl_b32 s13, s13, 12
  v_max_i32 v140, 0, v142
  v_lshlrev_b32 v140, 1, v140
  s_lshl3_add_u32 s14, s87, s20
  s_lshl_b32 s14, s14, 10
  buffer_load_dwordx4 v[208:211], v14, s[52:55], s14 offen
  buffer_load_dwordx2 v[212:213], v14, s[52:55], s14 offen offset:16
  buffer_load_ushort v140, v140, s[52:55], s13 offen
  v_and_b32 v5, 31, v1
  v_lshlrev_b32 v5, 5, v5
  v_add_u32 v5, 12615680, v5
  s_lshl4_add_u32 s3, s76, 0
  s_add_u32 m0, s91, 0
  s_nop 0
  buffer_load_dwordx4 v0, s[44:47], s3 offen lds
  s_lshl4_add_u32 s3, s76, 458752
  s_add_u32 m0, s91, 8192
  s_nop 0
  buffer_load_dwordx4 v0, s[44:47], s3 offen lds
  s_lshl4_add_u32 s3, s77, 0
  s_add_u32 m0, s91, 16384
  s_nop 0
  buffer_load_dwordx4 v0, s[44:47], s3 offen lds
  s_lshl4_add_u32 s3, s77, 458752
  s_add_u32 m0, s91, 24576
  s_nop 0
  buffer_load_dwordx4 v0, s[44:47], s3 offen lds
  s_mul_i32 s14, s29, 24576
  s_lshl_b32 s15, s90, 10
  s_add_u32 s15, s15, s14
  s_add_u32 s15, s15, 114688
  v_add_u32 v6, s15, v14
  s_waitcnt vmcnt(5)
  ds_write_b128 v6, v[210:213] offset:19680
  v_alignbit_b32 v214, v209, v208, 16
  v_alignbit_b32 v215, v210, v209, 16
  v_alignbit_b32 v216, v211, v210, 16
  v_alignbit_b32 v217, v212, v211, 16
  ds_write_b128 v6, v[214:217] offset:32
  v_mov_b32 v218, v209
  v_mov_b32 v219, v210
  v_mov_b32 v220, v211
  v_mov_b32 v221, v212
  ds_write_b128 v6, v[218:221] offset:4192
  v_alignbit_b32 v222, v210, v209, 16
  v_alignbit_b32 v223, v211, v210, 16
  v_alignbit_b32 v224, v212, v211, 16
  v_alignbit_b32 v225, v213, v212, 16
  ds_write_b128 v6, v[222:225] offset:15520
  s_lshl_b32 s15, s90, 8
  s_add_u32 s15, s15, s14
  s_add_u32 s15, s15, 129024
  v_lshl_add_u32 v7, v1, 2, s15
  v_mov_b32 v226, 0
  ds_write_b32 v7, v226
  v_cmp_le_i32 vcc, 0, v142
  s_waitcnt vmcnt(4)
  s_nop 0
  v_cndmask_b32 v140, 0, v140, vcc
  ds_write_b16 v141, v140
  buffer_load_dword v176, v5, s[48:51], 0 offen sc1
  s_lshl4_add_u32 s3, s78, 0
  s_add_u32 m0, s91, 32768
  s_nop 0
  buffer_load_dwordx4 v0, s[44:47], s3 offen lds
  s_lshl4_add_u32 s3, s78, 458752
  s_add_u32 m0, s91, 40960
  s_nop 0
  buffer_load_dwordx4 v0, s[44:47], s3 offen lds
  s_lshl4_add_u32 s3, s79, 0
  s_add_u32 m0, s91, 49152
  s_nop 0
  buffer_load_dwordx4 v0, s[44:47], s3 offen lds
  s_lshl4_add_u32 s3, s79, 458752
  s_add_u32 m0, s91, 57344
  s_nop 0
  buffer_load_dwordx4 v0, s[44:47], s3 offen lds
  s_waitcnt vmcnt(4)
  v_cmp_eq_u32 vcc, 1, v176
  s_nop 0
  s_cmp_eq_u64 vcc, -1
  s_cbranch_scc1 L_done_45
  s_movk_i32 s18, 4095
L_poll_46:
  s_sleep 2
  buffer_load_dword v176, v5, s[48:51], 0 offen sc1
  s_waitcnt vmcnt(0)
  v_cmp_eq_u32 vcc, 1, v176
  s_nop 0
  s_cmp_eq_u64 vcc, -1
  s_cbranch_scc1 L_done_45
  s_sub_u32 s18, s18, 1
  s_cbranch_scc0 L_poll_46
L_done_45:
  s_lshl3_add_u32 s13, s87, s20
  s_lshl_b32 s13, s13, 10
  s_add_u32 s13, s13, 8388608
  s_mul_i32 s14, s29, 20480
  s_add_u32 s14, s14, s91
  s_add_u32 m0, s14, 124928
  s_nop 0
  buffer_load_dwordx4 v14, s[48:51], s13 offen sc1 lds
  s_lshl1_add_u32 s88, s24, s28
  s_lshl_b32 s3, s89, 9
  s_add_u32 s88, s88, s3
  s_lshl_b32 s88, s88, 6
  v_and_b32 v168, 31, v1
  v_lshrrev_b32 v143, 5, v1
  v_lshlrev_b32 v143, 4, v143
  v_lshl_add_u32 v143, v168, 10, v143
  s_cmp_lt_u32 s20, 4
  s_cbranch_scc1 L_xs_47
  buffer_load_dwordx4 v[168:171], v143, s[40:43], s88 offen offset:0
  buffer_load_dwordx4 v[172:175], v143, s[40:43], s88 offen offset:32
L_xs_47:
  s_mov_b64 s[64:65], s[44:45]
  s_mov_b32 s66, 1835008
  s_mov_b32 s67, 0x20000
  s_lshl1_add_u32 s4, s35, s27
  s_lshl_b32 s4, s4, 10
  s_add_u32 s4, s4, 12582912
  buffer_load_dwordx2 v[120:121], v130, s[48:51], s4 offen offset:0 sc1
  buffer_load_dwordx2 v[122:123], v130, s[48:51], s4 offen offset:64 sc1
  s_waitcnt vmcnt(0)
  v_max3_u32 v124, v121, v123, v123
  v_cmp_eq_u32 vcc, -1, v124
  s_nop 0
  s_cmp_eq_u64 vcc, 0
  s_cbranch_scc1 L_done_48
  s_movk_i32 s18, 4095
L_poll_49:
  s_sleep 2
  buffer_load_dwordx2 v[120:121], v130, s[48:51], s4 offen offset:0 sc1
  buffer_load_dwordx2 v[122:123], v130, s[48:51], s4 offen offset:64 sc1
  s_waitcnt vmcnt(0)
  v_max3_u32 v124, v121, v123, v123
  v_cmp_eq_u32 vcc, -1, v124
  s_nop 0
  s_cmp_eq_u64 vcc, 0
  s_cbranch_scc1 L_done_48
  s_sub_u32 s18, s18, 1
  s_cbranch_scc0 L_poll_49
L_done_48:
  v_add_f32 v120, v120, v122
  v_add_f32 v121, v121, v123
  v_mul_f32 v120, 0xbb000000, v120
L_pad_69:
  s_cbranch_execz L_backS
  v_mul_f32 v121, 0x3b000000, v121
  v_fma_f32 v121, -v120, v120, v121
  v_max_f32 v121, 0, v121
  v_cvt_pk_bf16_f32 v240, v120, v120
  v_cvt_pk_bf16_f32 v121, v121, v121
  v_and_b32 v121, 0xffff0000, v121
  v_add_f32 v121, 0x3727c5ac, v121
  v_cvt_pk_bf16_f32 v121, v121, v121
  v_and_b32 v121, 0xffff0000, v121
  v_sqrt_f32 v121, v121
  s_nop 0
  v_cvt_pk_bf16_f32 v121, v121, v121
  v_and_b32 v121, 0xffff0000, v121
  v_rcp_f32 v122, v121
  v_mov_b32 v244, v240
  s_nop 1
  v_permlane32_swap_b32 v240, v244
  s_waitcnt vmcnt(0) lgkmcnt(0)
  s_barrier
  s_branch L_t0
L_last:
.section .rodata,"a"
.p2align 6
.amdhsa_kernel recurrent_scan__ssm_conv_h3__geglu_ffn__prompt_kernel
  .amdhsa_next_free_vgpr 256
  .amdhsa_next_free_sgpr 102
  .amdhsa_accum_offset 256
  .amdhsa_group_segment_fixed_size 0
  .amdhsa_kernarg_size 104
  .amdhsa_user_sgpr_count 2
  .amdhsa_user_sgpr_kernarg_segment_ptr 1
  .amdhsa_system_sgpr_workgroup_id_x 1
.end_amdhsa_kernel
```
